```python
import torch

def _softmax(x, axis=-1):
    return torch.softmax(x, dim=axis)
def _gelu(x):
    return torch.nn.functional.gelu(x, approximate="tanh")
def _silu(x):
    return torch.nn.functional.silu(x)
def _sigmoid(x):
    return torch.sigmoid(x)
def _layernorm(x, axis=-1, eps=1e-5):
    m = x.mean(dim=axis, keepdim=True)
    v = x.var(dim=axis, keepdim=True, unbiased=False)
    return (x - m) / torch.sqrt(v + eps)
def _scatter_add(tgt, idx, src, axis=0):
    return tgt.clone().index_add_(axis, idx, src)
def _segment_sum(src, seg, n):
    out = torch.zeros((n,) + src.shape[1:], dtype=src.dtype)
    return out.index_add_(0, seg, src)
def _pad(x, pw):
    flat = tuple(v for pair in reversed(pw) for v in pair)
    return torch.nn.functional.pad(x, flat)

kernel_name = 'sequential_preLN__softmax_full_mha__geglu_ffn__prompt'

def setup_inputs():

    _w = (lambda a: (lambda t: t.to(torch.bfloat16) if t.is_floating_point() else t)(torch.as_tensor(a)))
    def _A_setup():
        B, S, D = 1, 2048, 512
        return {
            "x": _w((lambda *s: torch.randn(*s, dtype=torch.bfloat16) * 0.05)(B, S, D)),
            "wqkv": _w((lambda *s: torch.randn(*s, dtype=torch.bfloat16) * 0.05)(D, 3 * D)),
            "wo": _w((lambda *s: torch.randn(*s, dtype=torch.bfloat16) * 0.05)(D, D)),
        }
    _A_in = _A_setup()

    def _B_setup():
        B, S, D, F = 1, 2048, 512, 1376
        return {
            "x": _w((lambda *s: torch.randn(*s, dtype=torch.bfloat16) * 0.05)(B, S, D)),
            "w_gate": _w((lambda *s: torch.randn(*s, dtype=torch.bfloat16) * 0.05)(D, F)),
            "w_up": _w((lambda *s: torch.randn(*s, dtype=torch.bfloat16) * 0.05)(D, F)),
            "w_down": _w((lambda *s: torch.randn(*s, dtype=torch.bfloat16) * 0.05)(F, D)),
        }
    _B_in = _B_setup()

    return {
        "A_x": _A_in["x"],
        "A_wqkv": _A_in["wqkv"],
        "A_wo": _A_in["wo"],
        "B_x": _B_in["x"],
        "B_w_gate": _B_in["w_gate"],
        "B_w_up": _B_in["w_up"],
        "B_w_down": _B_in["w_down"],
    }

def reference(A_x, A_wqkv, A_wo, B_x, B_w_gate, B_w_up, B_w_down):
    def _A_ref(x, wqkv, wo):
        B, S, D = x.shape
        H = 32; Dh = D // H
        qkv = (lambda x, *d: x.permute(*d))((x @ wqkv).reshape(B, S, 3, H, Dh), 2, 0, 3, 1, 4)
        q, k, v = qkv[0], qkv[1], qkv[2]
        scale = Dh ** -0.5
        scores = torch.einsum("bhqd,bhkd->bhqk", q, k) * scale
        p = _softmax(scores, axis=-1)
        o = torch.einsum("bhqk,bhkd->bhqd", p, v)
        return (lambda x, *d: x.permute(*d))(o, 0, 2, 1, 3).reshape(B, S, D) @ wo

    def _B_ref(x, w_gate, w_up, w_down):
        return (_gelu(x @ w_gate) * (x @ w_up)) @ w_down

    x = A_x
    h = x + _A_ref(_layernorm(x, axis=-1), A_wqkv, A_wo)
    h2 = h + _B_ref(_layernorm(h, axis=-1), B_w_gate, B_w_up, B_w_down)
    return h2
```

```asm
; @launch grid=(256,1,1) block=(768,1,1) lds=163840
.amdgcn_target "amdgcn-amd-amdhsa--gfx950"
.text
.globl sequential_preLN__softmax_full_mha__geglu_ffn__prompt_kernel
.p2align 12
.p2align 8
.type sequential_preLN__softmax_full_mha__geglu_ffn__prompt_kernel,@function
sequential_preLN__softmax_full_mha__geglu_ffn__prompt_kernel:
    s_cmp_ge_u32 s2, 256
    s_cbranch_scc1 sequential_preLN__softmax_full_mha__geglu_ffn__prompt_kernel_exit
    s_load_dwordx16 s[64:79], s[0:1], 0
    s_load_dwordx4 s[80:83], s[0:1], 64
    v_lshrrev_b32 v1, 6, v0
    v_and_b32 v0, 63, v0
    v_readfirstlane_b32 s24, v1
    s_mov_b32 s22, 0x1800000
    s_mov_b32 s23, 0x00020000
    s_and_b32 s25, s2, 6
    s_lshl_b32 s25, s25, 2
    s_bfe_u32 s27, s2, 0x30003
    s_add_u32 s25, s25, s27
    s_and_b32 s26, s2, 1
    s_lshl_b32 s26, s26, 2
    s_lshr_b32 s28, s2, 6
    s_add_u32 s26, s26, s28
    v_lshrrev_b32 v2, 5, v0
    s_cmp_lt_u32 s24, 4
    s_cbranch_scc1 sequential_preLN__softmax_full_mha__geglu_ffn__prompt_kernel_p1_load
    s_and_b32 s60, s2, 0xf8
    s_add_u32 s60, s60, s24
    s_sub_u32 s60, s60, 4
    s_lshl_b32 s60, s60, 7
    s_getpc_b64 s[62:63]
sequential_preLN__softmax_full_mha__geglu_ffn__prompt_kernel_p1_cw0:
    s_sub_u32 s62, s62, sequential_preLN__softmax_full_mha__geglu_ffn__prompt_kernel_p1_cw0-sequential_preLN__softmax_full_mha__geglu_ffn__prompt_kernel
    s_subb_u32 s63, s63, 0
    s_min_u32 s61, s60, sequential_preLN__softmax_full_mha__geglu_ffn__prompt_kernel_exit-sequential_preLN__softmax_full_mha__geglu_ffn__prompt_kernel
    s_load_dword s90, s[62:63], s61
    s_add_u32 s60, s60, 0x8000
    s_min_u32 s61, s60, sequential_preLN__softmax_full_mha__geglu_ffn__prompt_kernel_exit-sequential_preLN__softmax_full_mha__geglu_ffn__prompt_kernel
    s_load_dword s90, s[62:63], s61
    s_cmp_ge_u32 s24, 8
    s_cbranch_scc1 sequential_preLN__softmax_full_mha__geglu_ffn__prompt_kernel_p1_stat
    s_branch sequential_preLN__softmax_full_mha__geglu_ffn__prompt_kernel_p1_cons
sequential_preLN__softmax_full_mha__geglu_ffn__prompt_kernel_p1_load:
    v_lshrrev_b32 v1, 3, v0
    v_mul_u32_u24 v5, 3072, v1
    v_lshrrev_b32 v1, 2, v0
    v_and_b32 v1, 4, v1
    v_xor_b32 v1, v1, v0
    v_and_b32 v1, 7, v1
    v_lshl_add_u32 v5, v1, 4, v5
    s_lshl_b32 s59, s27, 2
    s_add_u32 s59, s59, s24
    s_mul_i32 s59, s59, 49152
    s_lshl_b32 s36, s26, 7
    s_add_u32 s59, s59, s36
    s_and_b32 s27, s27, 3
    v_lshlrev_b32 v1, 3, v2
    v_xor_b32 v1, v1, v0
    v_and_b32 v1, 31, v1
    v_lshl_add_u32 v1, s27, 4, v1
    v_and_b32 v1, 63, v1
    v_lshlrev_b32 v7, 10, v2
    v_lshl_add_u32 v7, v1, 4, v7
    v_xor_b32 v8, 512, v7
    s_lshl_b32 s31, s25, 16
    s_lshl_b32 s36, s24, 11
    s_add_u32 s31, s31, s36
    s_mul_i32 s29, s24, 1040
    s_mul_i32 s32, s24, 98304
    s_lshl_b32 s33, s26, 7
    s_add_u32 s32, s32, s33
    s_add_u32 s36, s28, 0
    s_and_b32 s36, s36, 3
    s_mul_i32 s44, s36, 8320
    s_add_u32 s44, s44, s29
    s_lshl_b32 s36, s36, 14
    s_add_u32 s48, s36, s31
    s_add_u32 s36, s27, 0
    s_and_b32 s36, s36, 3
    s_mul_i32 s52, s36, 393216
    s_add_u32 s52, s52, s32
    s_add_u32 s36, s28, 1
    s_and_b32 s36, s36, 3
    s_mul_i32 s45, s36, 8320
    s_add_u32 s45, s45, s29
    s_lshl_b32 s36, s36, 14
    s_add_u32 s49, s36, s31
    s_add_u32 s36, s27, 1
    s_and_b32 s36, s36, 3
    s_mul_i32 s53, s36, 393216
    s_add_u32 s53, s53, s32
    s_add_u32 s36, s28, 2
    s_and_b32 s36, s36, 3
    s_mul_i32 s46, s36, 8320
    s_add_u32 s46, s46, s29
    s_lshl_b32 s36, s36, 14
    s_add_u32 s50, s36, s31
    s_add_u32 s36, s27, 2
    s_and_b32 s36, s36, 3
    s_mul_i32 s54, s36, 393216
    s_add_u32 s54, s54, s32
    s_add_u32 s36, s28, 3
    s_and_b32 s36, s36, 3
    s_mul_i32 s47, s36, 8320
    s_add_u32 s47, s47, s29
    s_lshl_b32 s36, s36, 14
    s_add_u32 s51, s36, s31
    s_add_u32 s36, s27, 3
    s_and_b32 s36, s36, 3
    s_mul_i32 s55, s36, 393216
    s_add_u32 s55, s55, s32
    s_lshl_b32 s34, s24, 12
    s_add_u32 s34, s34, 66560
    s_mov_b32 s14, 2097152
    s_mov_b32 s15, 0x00020000
    s_mov_b32 s18, 1572864
    s_mov_b32 s19, 0x00020000
    s_waitcnt lgkmcnt(0)
    s_mov_b64 s[20:21], s[82:83]
    s_mov_b64 s[12:13], s[64:65]
    s_mov_b64 s[16:17], s[66:67]
    s_add_u32 s56, s66, s59
    s_addc_u32 s57, s67, 0
    s_add_u32 m0, s44, 0
    s_add_u32 s36, s48, 8192
    buffer_load_dwordx4 v7, s[12:15], s48 offen lds
    s_add_u32 m0, s44, 4160
    s_nop 0
    buffer_load_dwordx4 v7, s[12:15], s36 offen lds
    s_add_u32 m0, s34, 0
    s_add_u32 s36, s52, 1024
    buffer_load_dwordx4 v5, s[16:19], s36 offen offset:0 lds
    s_add_u32 s37, s52, 24576
    buffer_load_dwordx4 v5, s[16:19], s37 offen offset:1024 lds
    s_add_u32 s36, s52, 48128
    buffer_load_dwordx4 v5, s[16:19], s36 offen offset:2048 lds
    s_add_u32 s37, s52, 71680
    buffer_load_dwordx4 v5, s[16:19], s37 offen offset:3072 lds
    s_add_u32 m0, s45, 0
    s_add_u32 s36, s49, 8192
    buffer_load_dwordx4 v7, s[12:15], s49 offen lds
    s_add_u32 m0, s45, 4160
    s_nop 0
    buffer_load_dwordx4 v7, s[12:15], s36 offen lds
    s_add_u32 m0, s46, 0
    s_add_u32 s36, s50, 8192
    buffer_load_dwordx4 v7, s[12:15], s50 offen lds
    s_add_u32 m0, s46, 4160
    s_nop 0
    buffer_load_dwordx4 v7, s[12:15], s36 offen lds
    s_add_u32 m0, s47, 0
    s_add_u32 s36, s51, 8192
    buffer_load_dwordx4 v7, s[12:15], s51 offen lds
    s_add_u32 m0, s47, 4160
    s_nop 0
    buffer_load_dwordx4 v7, s[12:15], s36 offen lds
    s_add_u32 m0, s34, 16384
    s_add_u32 s36, s53, 1024
    buffer_load_dwordx4 v5, s[16:19], s36 offen offset:0 lds
    s_add_u32 s37, s53, 24576
    buffer_load_dwordx4 v5, s[16:19], s37 offen offset:1024 lds
    s_add_u32 s36, s53, 48128
    buffer_load_dwordx4 v5, s[16:19], s36 offen offset:2048 lds
    s_add_u32 s37, s53, 71680
    buffer_load_dwordx4 v5, s[16:19], s37 offen offset:3072 lds
    s_add_u32 m0, s44, 33280
    s_add_u32 s36, s48, 8192
    buffer_load_dwordx4 v8, s[12:15], s48 offen lds
    s_add_u32 m0, s44, 37440
    s_nop 0
    buffer_load_dwordx4 v8, s[12:15], s36 offen lds
    s_waitcnt vmcnt(6)
    s_barrier
    s_add_u32 m0, s45, 33280
    s_add_u32 s36, s49, 8192
    buffer_load_dwordx4 v8, s[12:15], s49 offen lds
    s_add_u32 m0, s45, 37440
    s_nop 0
    buffer_load_dwordx4 v8, s[12:15], s36 offen lds
    s_add_u32 m0, s46, 33280
    s_add_u32 s36, s50, 8192
    buffer_load_dwordx4 v8, s[12:15], s50 offen lds
    s_add_u32 m0, s46, 37440
    s_nop 0
    buffer_load_dwordx4 v8, s[12:15], s36 offen lds
    s_add_u32 m0, s47, 33280
    s_add_u32 s36, s51, 8192
    buffer_load_dwordx4 v8, s[12:15], s51 offen lds
    s_add_u32 m0, s47, 37440
    s_nop 0
    buffer_load_dwordx4 v8, s[12:15], s36 offen lds
    s_add_u32 m0, s34, 32768
    s_add_u32 s36, s54, 1024
    buffer_load_dwordx4 v5, s[16:19], s36 offen offset:0 lds
    s_add_u32 s37, s54, 24576
    buffer_load_dwordx4 v5, s[16:19], s37 offen offset:1024 lds
    s_add_u32 s36, s54, 48128
    buffer_load_dwordx4 v5, s[16:19], s36 offen offset:2048 lds
    s_add_u32 s37, s54, 71680
    buffer_load_dwordx4 v5, s[16:19], s37 offen offset:3072 lds
    s_waitcnt vmcnt(12)
    s_barrier
    s_add_u32 m0, s34, 49152
    s_add_u32 s36, s55, 1024
    buffer_load_dwordx4 v5, s[16:19], s36 offen offset:0 lds
    s_add_u32 s37, s55, 24576
    buffer_load_dwordx4 v5, s[16:19], s37 offen offset:1024 lds
    s_add_u32 s36, s55, 48128
    buffer_load_dwordx4 v5, s[16:19], s36 offen offset:2048 lds
    s_add_u32 s37, s55, 71680
    buffer_load_dwordx4 v5, s[16:19], s37 offen offset:3072 lds
    s_add_u32 m0, s34, 65536
    s_add_u32 s36, s52, 2048
    buffer_load_dwordx4 v5, s[16:19], s36 offen offset:0 lds
    s_add_u32 s37, s52, 25600
    buffer_load_dwordx4 v5, s[16:19], s37 offen offset:1024 lds
    s_add_u32 s36, s52, 49152
    buffer_load_dwordx4 v5, s[16:19], s36 offen offset:2048 lds
    s_add_u32 s37, s52, 72704
    buffer_load_dwordx4 v5, s[16:19], s37 offen offset:3072 lds
    s_waitcnt vmcnt(8)
    s_barrier
    s_add_u32 m0, s34, 0
    s_add_u32 s36, s53, 2048
    buffer_load_dwordx4 v5, s[16:19], s36 offen offset:0 lds
    s_add_u32 s37, s53, 25600
    buffer_load_dwordx4 v5, s[16:19], s37 offen offset:1024 lds
    s_add_u32 s36, s53, 49152
    buffer_load_dwordx4 v5, s[16:19], s36 offen offset:2048 lds
    s_add_u32 s37, s53, 72704
    buffer_load_dwordx4 v5, s[16:19], s37 offen offset:3072 lds
    s_waitcnt vmcnt(8)
    s_barrier
    s_add_u32 m0, s34, 16384
    s_add_u32 s36, s54, 2048
    buffer_load_dwordx4 v5, s[16:19], s36 offen offset:0 lds
    s_add_u32 s37, s54, 25600
    buffer_load_dwordx4 v5, s[16:19], s37 offen offset:1024 lds
    s_add_u32 s36, s54, 49152
    buffer_load_dwordx4 v5, s[16:19], s36 offen offset:2048 lds
    s_add_u32 s37, s54, 72704
    buffer_load_dwordx4 v5, s[16:19], s37 offen offset:3072 lds
    s_waitcnt vmcnt(8)
    s_barrier
    s_add_u32 m0, s34, 32768
    s_add_u32 s36, s55, 2048
    buffer_load_dwordx4 v5, s[16:19], s36 offen offset:0 lds
    s_add_u32 s37, s55, 25600
    buffer_load_dwordx4 v5, s[16:19], s37 offen offset:1024 lds
    s_add_u32 s36, s55, 49152
    buffer_load_dwordx4 v5, s[16:19], s36 offen offset:2048 lds
    s_add_u32 s37, s55, 72704
    buffer_load_dwordx4 v5, s[16:19], s37 offen offset:3072 lds
    s_waitcnt vmcnt(8)
    s_barrier
    s_add_u32 m0, s34, 49152
    s_add_u32 s36, s52, 0
    buffer_load_dwordx4 v5, s[16:19], s36 offen offset:0 lds
    s_add_u32 s37, s52, 23552
    buffer_load_dwordx4 v5, s[16:19], s37 offen offset:1024 lds
    s_add_u32 s36, s52, 47104
    buffer_load_dwordx4 v5, s[16:19], s36 offen offset:2048 lds
    s_add_u32 s37, s52, 70656
    buffer_load_dwordx4 v5, s[16:19], s37 offen offset:3072 lds
    s_waitcnt vmcnt(8)
    s_barrier
    s_add_u32 m0, s34, 65536
    s_add_u32 s36, s53, 0
    buffer_load_dwordx4 v5, s[16:19], s36 offen offset:0 lds
    s_add_u32 s37, s53, 23552
    buffer_load_dwordx4 v5, s[16:19], s37 offen offset:1024 lds
    s_add_u32 s36, s53, 47104
    buffer_load_dwordx4 v5, s[16:19], s36 offen offset:2048 lds
    s_add_u32 s37, s53, 70656
    buffer_load_dwordx4 v5, s[16:19], s37 offen offset:3072 lds
    s_waitcnt vmcnt(8)
    s_barrier
    s_add_u32 m0, s34, 0
    s_add_u32 s36, s54, 0
    buffer_load_dwordx4 v5, s[16:19], s36 offen offset:0 lds
    s_add_u32 s37, s54, 23552
    buffer_load_dwordx4 v5, s[16:19], s37 offen offset:1024 lds
    s_add_u32 s36, s54, 47104
    buffer_load_dwordx4 v5, s[16:19], s36 offen offset:2048 lds
    s_add_u32 s37, s54, 70656
    buffer_load_dwordx4 v5, s[16:19], s37 offen offset:3072 lds
    s_waitcnt vmcnt(8)
    s_barrier
    s_add_u32 m0, s34, 16384
    s_add_u32 s36, s55, 0
    buffer_load_dwordx4 v5, s[16:19], s36 offen offset:0 lds
    s_add_u32 s37, s55, 23552
    buffer_load_dwordx4 v5, s[16:19], s37 offen offset:1024 lds
    s_add_u32 s36, s55, 47104
    buffer_load_dwordx4 v5, s[16:19], s36 offen offset:2048 lds
    s_add_u32 s37, s55, 70656
    buffer_load_dwordx4 v5, s[16:19], s37 offen offset:3072 lds
    s_waitcnt vmcnt(8)
    s_barrier
    v_lshlrev_b32 v3, 4, v0
    s_and_b32 s25, s2, 7
    s_lshl_b32 s25, s25, 2
    s_bfe_u32 s27, s2, 0x20003
    s_add_u32 s25, s25, s27
    s_lshr_b32 s26, s2, 5
    s_lshl_b32 s30, s24, 12
    s_lshl_b32 s33, s26, 3
    s_lshl_b64 s[34:35], 0xff, s33
    s_and_b32 s40, s25, 7
    s_lshl_b32 s33, s40, 3
    s_lshl_b64 s[36:37], 0xff, s33
    s_or_b64 s[34:35], s[34:35], s[36:37]
    s_add_u32 s33, s33, 8
    s_lshl_b64 s[36:37], 0xff, s33
    s_or_b64 s[34:35], s[34:35], s[36:37]
    s_lshl_b32 s40, s40, 14
    s_lshl_b32 s27, s25, 6
    s_lshl_b32 s28, s26, 3
    s_add_u32 s27, s27, s28
    s_lshl_b32 s28, s27, 10
    s_lshl_b32 s31, s24, 11
    s_add_u32 s28, s28, s31
    s_add_u32 m0, s31, 131072
    s_lshl_b32 s29, s25, 17
    s_add_u32 s29, s29, 0x200000
    s_add_u32 s29, s29, s30
    s_lshl_b32 s27, s24, 2
    s_add_u32 s27, s27, 161792
    v_mov_b32 v5, s27
    v_mov_b32 v8, 1
    ds_write_b32 v5, v8
    s_waitcnt vmcnt(4)
    s_barrier
    v_mov_b32 v22, 148992
    ds_read_b64 v[22:23], v22
    s_waitcnt lgkmcnt(0)
    v_readfirstlane_b32 s84, v22
    v_readfirstlane_b32 s85, v23
    s_waitcnt vmcnt(0)
    s_barrier
    s_barrier
    s_setprio 3
    v_lshlrev_b32 v4, 3, v0
    s_lshl_b32 s61, s2, 9
    s_add_u32 s61, s61, 0x1780000
    s_cmp_lg_u32 s24, 0
    s_barrier
    s_cbranch_scc1 sequential_preLN__softmax_full_mha__geglu_ffn__prompt_kernel_p2_nop_kv
    s_mov_b64 exec, s[34:35]
    s_mov_b32 s63, 0x40000
sequential_preLN__softmax_full_mha__geglu_ffn__prompt_kernel_p2_poll_kv:
    v_mov_b32 v12, 0
    v_mov_b32 v13, 0
    buffer_atomic_or_x2 v[12:13], v4, s[20:23], s61 offen sc0 sc1
    s_sub_u32 s63, s63, 1
    s_waitcnt vmcnt(0)
    v_cmp_ne_u64 vcc, s[84:85], v[12:13]
    s_cbranch_scc1 sequential_preLN__softmax_full_mha__geglu_ffn__prompt_kernel_p2_polld_kv
    s_cbranch_vccz sequential_preLN__softmax_full_mha__geglu_ffn__prompt_kernel_p2_polld_kv
    s_mov_b64 exec, vcc
    s_sleep 1
    s_branch sequential_preLN__softmax_full_mha__geglu_ffn__prompt_kernel_p2_poll_kv
sequential_preLN__softmax_full_mha__geglu_ffn__prompt_kernel_p2_polld_kv:
    s_mov_b64 exec, -1
sequential_preLN__softmax_full_mha__geglu_ffn__prompt_kernel_p2_nop_kv:
    s_barrier
    buffer_load_dwordx4 v3, s[20:23], s28 offen sc1 lds
    buffer_load_dwordx4 v3, s[20:23], s28 offen offset:1024 sc1 lds
    s_add_u32 m0, s30, 0
    s_add_u32 s27, s29, s40
    buffer_load_dwordx4 v3, s[20:23], s27 offen offset:0 sc1 lds
    buffer_load_dwordx4 v3, s[20:23], s27 offen offset:1024 sc1 lds
    buffer_load_dwordx4 v3, s[20:23], s27 offen offset:2048 sc1 lds
    buffer_load_dwordx4 v3, s[20:23], s27 offen offset:3072 sc1 lds
    s_add_u32 s40, s40, 16384
    s_and_b32 s40, s40, 0x1ffff
    s_add_u32 m0, s30, 16384
    s_add_u32 s27, s29, s40
    buffer_load_dwordx4 v3, s[20:23], s27 offen offset:0 sc1 lds
    buffer_load_dwordx4 v3, s[20:23], s27 offen offset:1024 sc1 lds
    buffer_load_dwordx4 v3, s[20:23], s27 offen offset:2048 sc1 lds
    buffer_load_dwordx4 v3, s[20:23], s27 offen offset:3072 sc1 lds
    s_add_u32 s40, s40, 16384
    s_and_b32 s40, s40, 0x1ffff
    s_sub_u32 s46, 3, s24
    s_lshl_b32 s46, s46, 8
    s_add_u32 s46, s46, s2
    v_lshrrev_b32 v2, 5, v0
    s_cmp_ge_u32 s46, 352
    s_cselect_b32 s47, 256, 0
    s_cselect_b64 s[16:17], s[74:75], s[72:73]
    s_cselect_b32 s28, 352, 0
    s_sub_u32 s27, s46, s28
    s_and_b32 s34, s27, 15
    s_lshr_b32 s33, s27, 4
    s_mov_b32 s18, 1409024
    s_mov_b32 s19, 0x00020000
    s_lshl_b32 s27, s33, 1
    s_mul_i32 s28, s27, 43691
    s_lshr_b32 s28, s28, 17
    s_mul_i32 s35, s28, 186
    s_lshl_b32 s28, s27, 1
    s_add_u32 s35, s35, s28
    s_mul_i32 s28, s34, 12
    s_add_u32 s35, s35, s28
    s_lshl_b32 s35, s35, 10
    s_add_u32 s36, s35, 0xe00000
    s_lshl_b32 s27, s33, 1
    s_add_u32 s27, s27, 1
    s_mul_i32 s28, s27, 43691
    s_lshr_b32 s28, s28, 17
    s_mul_i32 s35, s28, 186
    s_lshl_b32 s28, s27, 1
    s_add_u32 s35, s35, s28
    s_mul_i32 s28, s34, 12
    s_add_u32 s35, s35, s28
    s_lshl_b32 s35, s35, 10
    s_add_u32 s37, s35, 0xe00000
    s_cmp_eq_u32 s33, 21
    s_cselect_b32 s37, 0x7fff0000, s37
    v_bfe_u32 v10, v0, 4, 1
    v_and_b32 v11, 15, v0
    v_lshlrev_b32 v11, 4, v11
    v_add_u32 v11, s47, v11
    v_lshl_add_u32 v7, v10, 10, v11
    v_lshl_add_u32 v7, v2, 9, v7
    s_lshl_b32 s39, s46, 8
    s_add_u32 s39, s39, 0xa40000
    v_lshlrev_b32 v9, 2, v0
    v_lshrrev_b32 v10, 2, v0
    v_and_b32 v10, 4, v10
    v_xor_b32 v10, v10, v0
    v_and_b32 v10, 7, v10
    v_lshlrev_b32 v10, 4, v10
    v_lshrrev_b32 v11, 3, v0
    v_lshl_add_u32 v22, v11, 10, v10
    v_mul_u32_u24 v11, 2752, v11
    v_add_u32 v6, v11, v10
    s_mul_i32 s38, s34, 88064
    s_lshl_b32 s28, s33, 7
    s_add_u32 s38, s38, s28
    s_add_u32 s35, s30, 139264
    v_and_b32 v16, 3, v0
    v_lshlrev_b32 v16, 3, v16
    v_lshrrev_b32 v10, 5, v0
    v_lshl_add_u32 v16, v10, 9, v16
    v_bfe_u32 v10, v0, 2, 2
    v_lshl_add_u32 v16, v10, 7, v16
    v_bfe_u32 v10, v0, 3, 1
    v_lshl_add_u32 v16, v10, 6, v16
    v_bfe_u32 v10, v0, 4, 1
    v_lshl_add_u32 v16, v10, 5, v16
    v_add_u32 v16, s35, v16
    v_xor_b32 v17, 64, v16
    v_lshrrev_b32 v18, 3, v0
    v_xor_b32 v10, v18, v0
    v_and_b32 v10, 7, v10
    v_lshlrev_b32 v18, 10, v18
    v_lshl_add_u32 v18, v10, 4, v18
    v_lshlrev_b32 v19, 7, v0
    v_min_u32 v23, 2688, v19
    s_and_b32 s47, s2, 1
    s_lshl_b32 s47, s47, 3
    s_lshr_b32 s27, s2, 5
    s_add_u32 s47, s47, s27
    s_mul_i32 s62, s47, 3
    v_lshrrev_b32 v14, 5, v0
    v_lshl_add_u32 v14, v14, 1, s62
    v_lshrrev_b32 v14, 1, v14
    v_min_u32 v14, 21, v14
    v_lshlrev_b32 v14, 4, v14
    v_bfe_u32 v10, v0, 4, 1
    v_mul_u32_u24 v10, 352, v10
    v_and_b32 v11, 15, v0
    v_add3_u32 v14, v14, v10, v11
    v_lshlrev_b32 v14, 3, v14
    s_min_u32 s27, s24, 2
    s_mul_i32 s62, s47, 96
    s_lshl_b32 s63, s27, 5
    s_add_u32 s62, s62, s63
    v_lshrrev_b32 v15, 5, v0
    v_lshl_add_u32 v15, v15, 4, s62
    v_and_b32 v10, 15, v0
    v_add_u32 v15, v15, v10
    v_and_b32 v10, 63, v15
    v_lshrrev_b32 v15, 6, v15
    v_lshlrev_b32 v15, 12, v15
    v_lshl_add_u32 v15, v10, 2, v15
    v_bfe_u32 v10, v0, 4, 1
    v_mul_u32_u24 v10, 90112, v10
    v_add_u32 v15, v15, v10
    s_lshl_b32 s27, s27, 8
    s_add_u32 s27, s27, 100352
    v_lshl_add_u32 v21, v0, 2, s27
    v_bfe_u32 v10, v0, 4, 1
    v_bfe_u32 v11, v0, 2, 1
    v_cmp_eq_u32 vcc, v10, v11
    v_mov_b32 v10, 0x3f803f80
    v_mov_b32 v1, 161792
    v_cndmask_b32 v160, 0, v10, vcc
    v_mov_b32 v161, v160
    v_mov_b32 v162, v160
    v_mov_b32 v163, v160
    v_mov_b32 v10, s84
    v_mov_b32 v11, s85
    s_waitcnt vmcnt(4)
    s_barrier
    s_barrier
    s_mov_b32 s63, 0x40000
sequential_preLN__softmax_full_mha__geglu_ffn__prompt_kernel_p2_poll_kv2:
    v_mov_b32 v12, 0
    v_mov_b32 v13, 0
    buffer_atomic_or_x2 v[12:13], v4, s[20:23], s61 offen sc0 sc1
    s_sub_u32 s63, s63, 1
    s_waitcnt vmcnt(0)
    v_cmp_ne_u64 vcc, s[84:85], v[12:13]
    s_cbranch_scc1 sequential_preLN__softmax_full_mha__geglu_ffn__prompt_kernel_p2_polld_kv2
    s_cbranch_vccz sequential_preLN__softmax_full_mha__geglu_ffn__prompt_kernel_p2_polld_kv2
    s_mov_b64 exec, vcc
    s_sleep 2
    s_branch sequential_preLN__softmax_full_mha__geglu_ffn__prompt_kernel_p2_poll_kv2
sequential_preLN__softmax_full_mha__geglu_ffn__prompt_kernel_p2_polld_kv2:
    s_mov_b64 exec, -1
    v_mov_b32 v8, 2
    ds_write_b32 v5, v8
    s_add_u32 m0, s30, 32768
    s_add_u32 s27, s29, s40
    buffer_load_dwordx4 v3, s[20:23], s27 offen offset:0 sc1 lds
    buffer_load_dwordx4 v3, s[20:23], s27 offen offset:1024 sc1 lds
    buffer_load_dwordx4 v3, s[20:23], s27 offen offset:2048 sc1 lds
    buffer_load_dwordx4 v3, s[20:23], s27 offen offset:3072 sc1 lds
    s_add_u32 s40, s40, 16384
    s_and_b32 s40, s40, 0x1ffff
    s_add_u32 m0, s30, 49152
    s_add_u32 s27, s29, s40
    buffer_load_dwordx4 v3, s[20:23], s27 offen offset:0 sc1 lds
    buffer_load_dwordx4 v3, s[20:23], s27 offen offset:1024 sc1 lds
    buffer_load_dwordx4 v3, s[20:23], s27 offen offset:2048 sc1 lds
    buffer_load_dwordx4 v3, s[20:23], s27 offen offset:3072 sc1 lds
    s_add_u32 s40, s40, 16384
    s_and_b32 s40, s40, 0x1ffff
    s_add_u32 m0, s30, 65536
    s_add_u32 s27, s29, s40
    buffer_load_dwordx4 v3, s[20:23], s27 offen offset:0 sc1 lds
    buffer_load_dwordx4 v3, s[20:23], s27 offen offset:1024 sc1 lds
    buffer_load_dwordx4 v3, s[20:23], s27 offen offset:2048 sc1 lds
    buffer_load_dwordx4 v3, s[20:23], s27 offen offset:3072 sc1 lds
    s_add_u32 s40, s40, 16384
    s_and_b32 s40, s40, 0x1ffff
    s_add_u32 m0, s30, 81920
    s_add_u32 s27, s29, s40
    buffer_load_dwordx4 v3, s[20:23], s27 offen offset:0 sc1 lds
    buffer_load_dwordx4 v3, s[20:23], s27 offen offset:1024 sc1 lds
    buffer_load_dwordx4 v3, s[20:23], s27 offen offset:2048 sc1 lds
    buffer_load_dwordx4 v3, s[20:23], s27 offen offset:3072 sc1 lds
    s_add_u32 s40, s40, 16384
    s_and_b32 s40, s40, 0x1ffff
    s_add_u32 m0, s30, 98304
    s_add_u32 s27, s29, s40
    buffer_load_dwordx4 v3, s[20:23], s27 offen offset:0 sc1 lds
    buffer_load_dwordx4 v3, s[20:23], s27 offen offset:1024 sc1 lds
    buffer_load_dwordx4 v3, s[20:23], s27 offen offset:2048 sc1 lds
    buffer_load_dwordx4 v3, s[20:23], s27 offen offset:3072 sc1 lds
    s_add_u32 s40, s40, 16384
    s_and_b32 s40, s40, 0x1ffff
    s_add_u32 m0, s30, 114688
    s_add_u32 s27, s29, s40
    buffer_load_dwordx4 v3, s[20:23], s27 offen offset:0 sc1 lds
    buffer_load_dwordx4 v3, s[20:23], s27 offen offset:1024 sc1 lds
    buffer_load_dwordx4 v3, s[20:23], s27 offen offset:2048 sc1 lds
    buffer_load_dwordx4 v3, s[20:23], s27 offen offset:3072 sc1 lds
    s_add_u32 s40, s40, 16384
    s_and_b32 s40, s40, 0x1ffff
    s_cmp_lt_u32 s46, 704
    s_cselect_b32 s38, s38, 0x7fff0000
    s_add_u32 m0, s35, 0
    s_nop 0
    buffer_load_dwordx4 v6, s[16:19], s38 offen lds
    s_add_u32 s38, s38, 22016
    s_add_u32 m0, s35, 1024
    s_nop 0
    buffer_load_dwordx4 v6, s[16:19], s38 offen lds
    s_add_u32 s38, s38, 22016
    s_add_u32 m0, s35, 2048
    s_nop 0
    buffer_load_dwordx4 v6, s[16:19], s38 offen lds
    s_add_u32 s38, s38, 22016
    s_add_u32 m0, s35, 3072
    s_nop 0
    buffer_load_dwordx4 v6, s[16:19], s38 offen lds
    s_add_u32 s38, s38, 22016
    s_waitcnt vmcnt(16)
    v_mov_b32 v8, 5
    ds_write_b32 v5, v8
    s_waitcnt vmcnt(4)
    v_mov_b32 v8, 9
    ds_write_b32 v5, v8
    s_mov_b64 s[12:13], s[68:69]
    s_mov_b32 s14, 0x80000
    s_mov_b32 s15, 0x00020000
    s_lshl_b32 s57, s24, 11
    s_lshl_b32 s58, s24, 14
    s_lshl_b32 s56, s26, 7
    s_add_u32 s56, s56, s58
    s_add_u32 s58, s56, 196608
    s_add_u32 s59, s58, 8192
    buffer_load_dwordx4 v[24:27], v22, s[12:15], s58 offen
    s_add_u32 s58, s58, 0x10000
    buffer_load_dwordx4 v[28:31], v22, s[12:15], s59 offen
    s_add_u32 s59, s58, 8192
    buffer_load_dwordx4 v[32:35], v22, s[12:15], s58 offen
    s_add_u32 s58, s58, 0x10000
    buffer_load_dwordx4 v[36:39], v22, s[12:15], s59 offen
    s_add_u32 s59, s58, 8192
    buffer_load_dwordx4 v[40:43], v22, s[12:15], s58 offen
    s_add_u32 s58, s58, 0x10000
    buffer_load_dwordx4 v[44:47], v22, s[12:15], s59 offen
    s_add_u32 s59, s58, 8192
    buffer_load_dwordx4 v[48:51], v22, s[12:15], s58 offen
    s_add_u32 s58, s58, 0x10000
    buffer_load_dwordx4 v[52:55], v22, s[12:15], s59 offen
    s_add_u32 s59, s58, 8192
    buffer_load_dwordx4 v[56:59], v22, s[12:15], s58 offen
    s_add_u32 s58, s58, 0x10000
    buffer_load_dwordx4 v[60:63], v22, s[12:15], s59 offen
    s_lshl_b32 s58, s25, 16
    s_add_u32 s56, s56, s58
    s_mov_b64 s[12:13], s[64:65]
    s_mov_b32 s14, 0x200000
    s_mov_b32 s15, 0x00020000
    s_add_u32 s58, s56, 8192
    buffer_load_dwordx4 v[64:67], v18, s[12:15], s56 offen
    buffer_load_dwordx4 v[68:71], v18, s[12:15], s58 offen
    s_cmp_lt_u32 s46, 704
    s_cbranch_scc0 sequential_preLN__softmax_full_mha__geglu_ffn__prompt_kernel_p2_notask
    s_waitcnt vmcnt(12)
    ds_read_b64_tr_b16 v[144:145], v16 offset:0
    ds_read_b64_tr_b16 v[146:147], v16 offset:1024
    ds_read_b64_tr_b16 v[148:149], v17 offset:0
    ds_read_b64_tr_b16 v[150:151], v17 offset:1024
    ds_read_b64_tr_b16 v[152:153], v16 offset:2048
    ds_read_b64_tr_b16 v[154:155], v16 offset:3072
    ds_read_b64_tr_b16 v[156:157], v17 offset:2048
    ds_read_b64_tr_b16 v[158:159], v17 offset:3072
    s_waitcnt lgkmcnt(0)
    buffer_store_dwordx4 v[144:147], v7, s[20:23], s36 offen sc1
    s_add_u32 s36, s36, 6144
    v_mfma_f32_16x16x32_bf16 v[136:139], v[160:163], v[144:147], 0
    buffer_store_dwordx4 v[148:151], v7, s[20:23], s37 offen sc1
    s_add_u32 s37, s37, 6144
    v_mfma_f32_16x16x32_bf16 v[140:143], v[160:163], v[148:151], 0
    buffer_store_dwordx4 v[152:155], v7, s[20:23], s36 offen sc1
    v_mfma_f32_16x16x32_bf16 v[136:139], v[160:163], v[152:155], v[136:139]
    buffer_store_dwordx4 v[156:159], v7, s[20:23], s37 offen sc1
    v_mfma_f32_16x16x32_bf16 v[140:143], v[160:163], v[156:159], v[140:143]
    s_lshl_b32 s27, s46, 3
    s_add_u32 s27, s27, 0xac0000
    s_mov_b64 exec, 0xffffffff
    s_nop 4
    buffer_store_dword v136, v9, s[20:23], s39 offen sc1
    buffer_store_dword v140, v9, s[20:23], s39 offen offset:128 sc1
    s_mov_b64 exec, 1
    s_waitcnt vmcnt(0)
    buffer_store_dwordx2 v[10:11], v3, s[20:23], s27 offen sc1
    s_mov_b64 exec, -1
sequential_preLN__softmax_full_mha__geglu_ffn__prompt_kernel_p2_notask:
    s_waitcnt vmcnt(0)
    v_mov_b32 v8, 10
    ds_write_b32 v5, v8
    s_lshr_b32 s33, s2, 3
    s_lshl_b32 s33, s33, 2
    s_add_u32 s33, s33, s24
sequential_preLN__softmax_full_mha__geglu_ffn__prompt_kernel_p2_stg:
    ds_read_b128 v[156:159], v1
    s_waitcnt lgkmcnt(0)
    v_min3_u32 v156, v156, v157, v158
    v_min_u32 v156, v156, v159
    v_cmp_gt_u32 vcc, 10, v156
    s_sleep 16
    s_cbranch_vccnz sequential_preLN__softmax_full_mha__geglu_ffn__prompt_kernel_p2_stg
    s_cmp_lt_u32 s24, 2
    s_cbranch_scc1 sequential_preLN__softmax_full_mha__geglu_ffn__prompt_kernel_p2_pre01
    s_mov_b64 s[16:17], s[68:69]
    s_mov_b32 s18, 0x80000
    s_mov_b32 s19, 0x00020000
    s_and_b32 s52, s24, 1
    s_lshl_b32 s53, s52, 15
    s_lshl_b32 s52, s52, 12
    s_lshr_b32 s54, s2, 5
    s_lshl_b32 s54, s54, 7
    s_add_u32 s53, s53, s54
    s_add_u32 m0, s52, 131072
    s_add_u32 s54, s53, 7168
    buffer_load_dwordx4 v22, s[16:19], s53 offen lds
    s_add_u32 s55, s53, 14336
    buffer_load_dwordx4 v22, s[16:19], s54 offen offset:1024 lds
    s_add_u32 s54, s53, 21504
    buffer_load_dwordx4 v22, s[16:19], s55 offen offset:2048 lds
    s_add_u32 s53, s53, 0x10000
    buffer_load_dwordx4 v22, s[16:19], s54 offen offset:3072 lds
    s_add_u32 m0, s52, 139264
    s_add_u32 s54, s53, 7168
    buffer_load_dwordx4 v22, s[16:19], s53 offen lds
    s_add_u32 s55, s53, 14336
    buffer_load_dwordx4 v22, s[16:19], s54 offen offset:1024 lds
    s_add_u32 s54, s53, 21504
    buffer_load_dwordx4 v22, s[16:19], s55 offen offset:2048 lds
    s_add_u32 s53, s53, 0x10000
    buffer_load_dwordx4 v22, s[16:19], s54 offen offset:3072 lds
    s_add_u32 m0, s52, 147456
    s_add_u32 s54, s53, 7168
    buffer_load_dwordx4 v22, s[16:19], s53 offen lds
    s_add_u32 s55, s53, 14336
    buffer_load_dwordx4 v22, s[16:19], s54 offen offset:1024 lds
    s_add_u32 s54, s53, 21504
    buffer_load_dwordx4 v22, s[16:19], s55 offen offset:2048 lds
    s_add_u32 s53, s53, 0x10000
    buffer_load_dwordx4 v22, s[16:19], s54 offen offset:3072 lds
sequential_preLN__softmax_full_mha__geglu_ffn__prompt_kernel_p2_pre01:
    s_and_b32 s48, s24, 1
    s_mul_i32 s48, s48, 6144
    s_and_b32 s49, s2, 1
    s_lshl_b32 s49, s49, 3
    s_lshr_b32 s51, s2, 5
    s_add_u32 s49, s49, s51
    s_mul_i32 s49, s49, 196608
    s_add_u32 s49, s49, 0xe00000
    s_add_u32 s49, s49, s48
    s_mov_b32 s50, s49
    s_mov_b32 s62, 0xac0000
    s_mov_b32 s63, 0x40000
sequential_preLN__softmax_full_mha__geglu_ffn__prompt_kernel_p2_poll_ftg:
    buffer_load_dwordx2 v[12:13], v14, s[20:23], s62 offen sc1
    s_sub_u32 s63, s63, 1
    s_waitcnt vmcnt(0)
    v_cmp_ne_u64 vcc, s[84:85], v[12:13]
    s_cbranch_scc1 sequential_preLN__softmax_full_mha__geglu_ffn__prompt_kernel_p2_polld_ftg
    s_cbranch_vccz sequential_preLN__softmax_full_mha__geglu_ffn__prompt_kernel_p2_polld_ftg
    s_mov_b64 exec, vcc
    s_sleep 16
    s_branch sequential_preLN__softmax_full_mha__geglu_ffn__prompt_kernel_p2_poll_ftg
sequential_preLN__softmax_full_mha__geglu_ffn__prompt_kernel_p2_polld_ftg:
    s_mov_b64 exec, -1
    s_mov_b32 s62, 0xa40000
    buffer_load_dword v144, v15, s[20:23], s62 offen offset:0 sc1
    buffer_load_dword v145, v15, s[20:23], s62 offen offset:256 sc1
    buffer_load_dword v146, v15, s[20:23], s62 offen offset:512 sc1
    buffer_load_dword v147, v15, s[20:23], s62 offen offset:768 sc1
    buffer_load_dword v148, v15, s[20:23], s62 offen offset:1024 sc1
    buffer_load_dword v149, v15, s[20:23], s62 offen offset:1280 sc1
    buffer_load_dword v150, v15, s[20:23], s62 offen offset:1536 sc1
    buffer_load_dword v151, v15, s[20:23], s62 offen offset:1792 sc1
    buffer_load_dword v152, v15, s[20:23], s62 offen offset:2048 sc1
    buffer_load_dword v153, v15, s[20:23], s62 offen offset:2304 sc1
    buffer_load_dword v154, v15, s[20:23], s62 offen offset:2560 sc1
    buffer_load_dword v155, v15, s[20:23], s62 offen offset:2816 sc1
    buffer_load_dword v156, v15, s[20:23], s62 offen offset:3072 sc1
    buffer_load_dword v157, v15, s[20:23], s62 offen offset:3328 sc1
    buffer_load_dword v158, v15, s[20:23], s62 offen offset:3584 sc1
    buffer_load_dword v159, v15, s[20:23], s62 offen offset:3840 sc1
    s_mul_i32 s59, s24, 3072
    s_sub_u32 s58, s49, s48
    s_add_u32 s58, s58, s59
    buffer_load_dwordx4 v[72:75], v3, s[20:23], s58 offen offset:0 sc1
    buffer_load_dwordx4 v[76:79], v3, s[20:23], s58 offen offset:1024 sc1
    buffer_load_dwordx4 v[80:83], v3, s[20:23], s58 offen offset:2048 sc1
    s_add_u32 s58, s58, 12288
    buffer_load_dwordx4 v[84:87], v3, s[20:23], s58 offen offset:0 sc1
    buffer_load_dwordx4 v[88:91], v3, s[20:23], s58 offen offset:1024 sc1
    buffer_load_dwordx4 v[92:95], v3, s[20:23], s58 offen offset:2048 sc1
    s_add_u32 s58, s58, 12288
    buffer_load_dwordx4 v[96:99], v3, s[20:23], s58 offen offset:0 sc1
    buffer_load_dwordx4 v[100:103], v3, s[20:23], s58 offen offset:1024 sc1
    buffer_load_dwordx4 v[104:107], v3, s[20:23], s58 offen offset:2048 sc1
    s_add_u32 s58, s58, 12288
    buffer_load_dwordx4 v[108:111], v3, s[20:23], s58 offen offset:0 sc1
    buffer_load_dwordx4 v[112:115], v3, s[20:23], s58 offen offset:1024 sc1
    buffer_load_dwordx4 v[116:119], v3, s[20:23], s58 offen offset:2048 sc1
    s_add_u32 s58, s58, 12288
    buffer_load_dwordx4 v[120:123], v3, s[20:23], s58 offen offset:0 sc1
    buffer_load_dwordx4 v[124:127], v3, s[20:23], s58 offen offset:1024 sc1
    buffer_load_dwordx4 v[128:131], v3, s[20:23], s58 offen offset:2048 sc1
    s_add_u32 s58, s58, 12288
    buffer_load_dwordx4 v[132:135], v3, s[20:23], s58 offen offset:0 sc1
    buffer_load_dwordx4 v[136:139], v3, s[20:23], s58 offen offset:1024 sc1
    buffer_load_dwordx4 v[140:143], v3, s[20:23], s58 offen offset:2048 sc1
    s_add_u32 s58, s58, 12288
    s_add_u32 s50, s50, 61440
    s_waitcnt vmcnt(0)
    s_and_b32 s32, s2, 1
    s_lshl_b32 s32, s32, 3
    s_lshr_b32 s27, s33, 4
    s_add_u32 s32, s32, s27
    s_mul_i32 s32, s32, 196608
    s_and_b32 s27, s33, 15
    s_lshl_b32 s27, s27, 13
    s_add_u32 s32, s32, s27
    s_add_u32 s32, s32, 0xe10000
    buffer_load_dword v163, v19, s[20:23], s32 offen sc1
    s_mov_b64 s[12:13], s[76:77]
    s_mov_b32 s14, 0x158000
    s_mov_b32 s15, 0x00020000
    s_mul_i32 s27, s33, 11008
    buffer_load_dword v160, v19, s[12:15], s27 offen
    s_add_u32 s27, s27, 8192
    buffer_load_dword v161, v23, s[12:15], s27 offen
    s_lshl_b32 s62, s2, 9
    s_lshl_b32 s63, s24, 17
    s_add_u32 s62, s62, s63
    s_add_u32 s62, s62, 0x1780000
    v_lshlrev_b32 v14, 3, v0
    v_mov_b32 v16, 0
    v_mov_b32 v17, 0
    buffer_atomic_or_x2 v[16:17], v14, s[20:23], s62 offen sc1
    s_setprio 0
    s_cmp_ge_u32 s24, 2
    s_cbranch_scc1 sequential_preLN__softmax_full_mha__geglu_ffn__prompt_kernel_role_w
    s_branch sequential_preLN__softmax_full_mha__geglu_ffn__prompt_kernel_pg_ra
.p2align 12
sequential_preLN__softmax_full_mha__geglu_ffn__prompt_kernel_pg_ra:
    s_and_b32 s54, s2, 7
    s_lshl_b32 s54, s54, 2
    s_bfe_u32 s55, s2, 0x20003
    s_add_u32 s54, s54, s55
    s_mul_i32 s54, s54, 65536
    s_add_u32 s54, s54, 0x600000
    s_and_b32 s52, s24, 1
    s_lshl_b32 s52, s52, 12
    s_mov_b32 s53, s52
    s_mov_b32 s18, 65536
    s_mov_b32 s19, 0x00020000
    s_add_u32 s16, s82, s54
    s_addc_u32 s17, s83, 0
    s_and_b32 s48, s24, 1
    s_mul_i32 s48, s48, 4096
    s_and_b32 s49, s2, 6
    s_lshl_b32 s49, s49, 1
    s_bfe_u32 s51, s2, 0x20003
    s_add_u32 s49, s49, s51
    s_lshl_b32 s49, s49, 17
    s_add_u32 s49, s49, 0x800000
    s_add_u32 s49, s49, s48
    s_mov_b32 s50, s49
    s_barrier
    s_add_u32 s62, s57, 0x20000
    v_add_u32 v2, s62, v3
    ds_write_b128 v2, v[24:27] offset:24576
    ds_write_b128 v2, v[28:31] offset:25600
    s_add_u32 s62, s57, 0x10000
    v_add_u32 v2, s62, v3
    ds_write_b128 v2, v[32:35] offset:0
    ds_write_b128 v2, v[36:39] offset:1024
    ds_write_b128 v2, v[40:43] offset:8192
    ds_write_b128 v2, v[44:47] offset:9216
    ds_write_b128 v2, v[48:51] offset:16384
    ds_write_b128 v2, v[52:55] offset:17408
    ds_write_b128 v2, v[56:59] offset:24576
    ds_write_b128 v2, v[60:63] offset:25600
    ds_write_b128 v2, v[64:67] offset:32768
    ds_write_b128 v2, v[68:71] offset:33792
    v_add_f32 v144, v144, v145
    v_add_f32 v144, v144, v146
    v_add_f32 v144, v144, v147
    v_add_f32 v144, v144, v148
    v_add_f32 v144, v144, v149
    v_add_f32 v144, v144, v150
    v_add_f32 v144, v144, v151
    v_add_f32 v144, v144, v152
    v_add_f32 v144, v144, v153
    v_add_f32 v144, v144, v154
    v_add_f32 v144, v144, v155
    v_add_f32 v144, v144, v156
    v_add_f32 v144, v144, v157
    v_add_f32 v144, v144, v158
    v_add_f32 v144, v144, v159
    v_cvt_pk_bf16_f32 v145, v144, v144
    v_lshlrev_b32 v145, 16, v145
    v_sub_f32 v145, v144, v145
    v_cvt_pk_bf16_f32 v20, v144, v145
    v_lshlrev_b32 v1, 3, v0
    s_lshl_b32 s61, s2, 9
    s_add_u32 s61, s61, 0x17a0000
    s_cmp_lg_u32 s24, 0
    s_barrier
    s_cbranch_scc1 sequential_preLN__softmax_full_mha__geglu_ffn__prompt_kernel_ra_nop_act
    s_mov_b32 s63, 0x40000
sequential_preLN__softmax_full_mha__geglu_ffn__prompt_kernel_ra_poll_act:
    v_mov_b32 v4, 0
    v_mov_b32 v5, 0
    buffer_atomic_or_x2 v[4:5], v1, s[20:23], s61 offen sc0 sc1
    s_sub_u32 s63, s63, 1
    s_waitcnt vmcnt(0)
    v_cmp_ne_u64 vcc, s[84:85], v[4:5]
    s_cbranch_scc1 sequential_preLN__softmax_full_mha__geglu_ffn__prompt_kernel_ra_polld_act
    s_cbranch_vccz sequential_preLN__softmax_full_mha__geglu_ffn__prompt_kernel_ra_polld_act
    s_mov_b64 exec, vcc
    s_sleep 1
    s_branch sequential_preLN__softmax_full_mha__geglu_ffn__prompt_kernel_ra_poll_act
sequential_preLN__softmax_full_mha__geglu_ffn__prompt_kernel_ra_polld_act:
    s_mov_b64 exec, -1
sequential_preLN__softmax_full_mha__geglu_ffn__prompt_kernel_ra_nop_act:
    s_barrier
    s_waitcnt lgkmcnt(0)
    s_add_u32 m0, s52, 0
    s_nop 0
    buffer_load_dwordx4 v3, s[16:19], s53 offen offset:0 sc1 lds
    buffer_load_dwordx4 v3, s[16:19], s53 offen offset:1024 sc1 lds
    buffer_load_dwordx4 v3, s[16:19], s53 offen offset:2048 sc1 lds
    buffer_load_dwordx4 v3, s[16:19], s53 offen offset:3072 sc1 lds
    s_add_u32 m0, s52, 8192
    s_add_u32 s53, s53, 8192
    buffer_load_dwordx4 v3, s[16:19], s53 offen offset:0 sc1 lds
    buffer_load_dwordx4 v3, s[16:19], s53 offen offset:1024 sc1 lds
    buffer_load_dwordx4 v3, s[16:19], s53 offen offset:2048 sc1 lds
    buffer_load_dwordx4 v3, s[16:19], s53 offen offset:3072 sc1 lds
    s_add_u32 m0, s52, 16384
    s_add_u32 s53, s53, 8192
    buffer_load_dwordx4 v3, s[16:19], s53 offen offset:0 sc1 lds
    buffer_load_dwordx4 v3, s[16:19], s53 offen offset:1024 sc1 lds
    buffer_load_dwordx4 v3, s[16:19], s53 offen offset:2048 sc1 lds
    buffer_load_dwordx4 v3, s[16:19], s53 offen offset:3072 sc1 lds
    s_add_u32 m0, s52, 24576
    s_add_u32 s53, s53, 8192
    buffer_load_dwordx4 v3, s[16:19], s53 offen offset:0 sc1 lds
    buffer_load_dwordx4 v3, s[16:19], s53 offen offset:1024 sc1 lds
    buffer_load_dwordx4 v3, s[16:19], s53 offen offset:2048 sc1 lds
    buffer_load_dwordx4 v3, s[16:19], s53 offen offset:3072 sc1 lds
    s_add_u32 m0, s52, 32768
    s_add_u32 s53, s53, 8192
    buffer_load_dwordx4 v3, s[16:19], s53 offen offset:0 sc1 lds
    buffer_load_dwordx4 v3, s[16:19], s53 offen offset:1024 sc1 lds
    buffer_load_dwordx4 v3, s[16:19], s53 offen offset:2048 sc1 lds
    buffer_load_dwordx4 v3, s[16:19], s53 offen offset:3072 sc1 lds
    s_waitcnt vmcnt(16)
    s_barrier
    s_add_u32 m0, s52, 40960
    s_add_u32 s53, s53, 8192
    buffer_load_dwordx4 v3, s[16:19], s53 offen offset:0 sc1 lds
    buffer_load_dwordx4 v3, s[16:19], s53 offen offset:1024 sc1 lds
    buffer_load_dwordx4 v3, s[16:19], s53 offen offset:2048 sc1 lds
    buffer_load_dwordx4 v3, s[16:19], s53 offen offset:3072 sc1 lds
    s_waitcnt vmcnt(16)
    s_barrier
    s_add_u32 m0, s52, 49152
    s_add_u32 s53, s53, 8192
    buffer_load_dwordx4 v3, s[16:19], s53 offen offset:0 sc1 lds
    buffer_load_dwordx4 v3, s[16:19], s53 offen offset:1024 sc1 lds
    buffer_load_dwordx4 v3, s[16:19], s53 offen offset:2048 sc1 lds
    buffer_load_dwordx4 v3, s[16:19], s53 offen offset:3072 sc1 lds
    s_waitcnt vmcnt(16)
    s_barrier
    s_add_u32 m0, s52, 57344
    s_add_u32 s53, s53, 8192
    buffer_load_dwordx4 v3, s[16:19], s53 offen offset:0 sc1 lds
    buffer_load_dwordx4 v3, s[16:19], s53 offen offset:1024 sc1 lds
    buffer_load_dwordx4 v3, s[16:19], s53 offen offset:2048 sc1 lds
    buffer_load_dwordx4 v3, s[16:19], s53 offen offset:3072 sc1 lds
    s_waitcnt vmcnt(16)
    s_barrier
    s_waitcnt vmcnt(12)
    s_barrier
    s_and_b32 s54, s2, 7
    s_lshl_b32 s54, s54, 2
    s_bfe_u32 s55, s2, 0x20003
    s_add_u32 s54, s54, s55
    s_mul_i32 s54, s54, 176128
    s_add_u32 s54, s54, 0x1200000
    s_and_b32 s52, s24, 1
    s_lshl_b32 s52, s52, 12
    s_mov_b32 s53, s52
    s_mov_b32 s18, 176128
    s_mov_b32 s19, 0x00020000
    s_add_u32 s16, s82, s54
    s_addc_u32 s17, s83, 0
    s_waitcnt vmcnt(8)
    s_barrier
    s_waitcnt vmcnt(4)
    s_barrier
    s_waitcnt vmcnt(0)
    s_barrier
    s_cmp_ge_u32 s47, 15
    s_cbranch_scc1 sequential_preLN__softmax_full_mha__geglu_ffn__prompt_kernel_ra_empty
    s_barrier
    s_add_u32 s62, s59, 0x10000
    v_add_u32 v1, s62, v3
    ds_write_b128 v1, v[72:75] offset:40960
    ds_write_b128 v1, v[76:79] offset:41984
    ds_write_b128 v1, v[80:83] offset:43008
    ds_write_b128 v1, v[84:87] offset:53248
    ds_write_b128 v1, v[88:91] offset:54272
    ds_write_b128 v1, v[92:95] offset:55296
    s_barrier
    s_add_u32 s62, s59, 0x0
    v_add_u32 v1, s62, v3
    ds_write_b128 v1, v[120:123] offset:49152
    ds_write_b128 v1, v[124:127] offset:50176
    ds_write_b128 v1, v[128:131] offset:51200
    ds_write_b128 v1, v[132:135] offset:61440
    ds_write_b128 v1, v[136:139] offset:62464
    ds_write_b128 v1, v[140:143] offset:63488
    s_add_u32 s62, s59, 0x20000
    v_add_u32 v1, s62, v3
    ds_write_b128 v1, v[96:99] offset:0
    ds_write_b128 v1, v[100:103] offset:1024
    ds_write_b128 v1, v[104:107] offset:2048
    ds_write_b128 v1, v[108:111] offset:12288
    ds_write_b128 v1, v[112:115] offset:13312
    ds_write_b128 v1, v[116:119] offset:14336
    ds_write_b32 v21, v20
    s_waitcnt lgkmcnt(0)
    s_barrier
    s_add_u32 m0, s48, 0
    s_nop 0
    buffer_load_dwordx4 v3, s[20:23], s50 offen offset:0 sc1 lds
    buffer_load_dwordx4 v3, s[20:23], s50 offen offset:1024 sc1 lds
    buffer_load_dwordx4 v3, s[20:23], s50 offen offset:2048 sc1 lds
    buffer_load_dwordx4 v3, s[20:23], s50 offen offset:3072 sc1 lds
    s_add_u32 m0, s48, 8192
    s_add_u32 s50, s50, 8192
    buffer_load_dwordx4 v3, s[20:23], s50 offen offset:0 sc1 lds
    buffer_load_dwordx4 v3, s[20:23], s50 offen offset:1024 sc1 lds
    buffer_load_dwordx4 v3, s[20:23], s50 offen offset:2048 sc1 lds
    buffer_load_dwordx4 v3, s[20:23], s50 offen offset:3072 sc1 lds
    s_add_u32 m0, s48, 16384
    s_add_u32 s50, s50, 8192
    buffer_load_dwordx4 v3, s[20:23], s50 offen offset:0 sc1 lds
    buffer_load_dwordx4 v3, s[20:23], s50 offen offset:1024 sc1 lds
    buffer_load_dwordx4 v3, s[20:23], s50 offen offset:2048 sc1 lds
    buffer_load_dwordx4 v3, s[20:23], s50 offen offset:3072 sc1 lds
    s_add_u32 m0, s48, 24576
    s_add_u32 s50, s50, 8192
    buffer_load_dwordx4 v3, s[20:23], s50 offen offset:0 sc1 lds
    buffer_load_dwordx4 v3, s[20:23], s50 offen offset:1024 sc1 lds
    buffer_load_dwordx4 v3, s[20:23], s50 offen offset:2048 sc1 lds
    buffer_load_dwordx4 v3, s[20:23], s50 offen offset:3072 sc1 lds
    s_waitcnt vmcnt(12)
    s_barrier
    s_add_u32 m0, s48, 32768
    s_add_u32 s50, s50, 8192
    buffer_load_dwordx4 v3, s[20:23], s50 offen offset:0 sc1 lds
    buffer_load_dwordx4 v3, s[20:23], s50 offen offset:1024 sc1 lds
    buffer_load_dwordx4 v3, s[20:23], s50 offen offset:2048 sc1 lds
    buffer_load_dwordx4 v3, s[20:23], s50 offen offset:3072 sc1 lds
    s_waitcnt vmcnt(12)
    s_barrier
    s_add_u32 m0, s48, 40960
    s_add_u32 s50, s50, 8192
    buffer_load_dwordx4 v3, s[20:23], s50 offen offset:0 sc1 lds
    buffer_load_dwordx4 v3, s[20:23], s50 offen offset:1024 sc1 lds
    buffer_load_dwordx4 v3, s[20:23], s50 offen offset:2048 sc1 lds
    buffer_load_dwordx4 v3, s[20:23], s50 offen offset:3072 sc1 lds
    s_waitcnt vmcnt(8)
    s_barrier
    s_add_u32 m0, s48, 0
    s_add_u32 s50, s50, 8192
    buffer_load_dwordx4 v3, s[20:23], s50 offen offset:0 sc1 lds
    buffer_load_dwordx4 v3, s[20:23], s50 offen offset:1024 sc1 lds
    buffer_load_dwordx4 v3, s[20:23], s50 offen offset:2048 sc1 lds
    buffer_load_dwordx4 v3, s[20:23], s50 offen offset:3072 sc1 lds
    s_add_u32 m0, s48, 8192
    s_add_u32 s50, s50, 8192
    buffer_load_dwordx4 v3, s[20:23], s50 offen offset:0 sc1 lds
    buffer_load_dwordx4 v3, s[20:23], s50 offen offset:1024 sc1 lds
    buffer_load_dwordx4 v3, s[20:23], s50 offen offset:2048 sc1 lds
    buffer_load_dwordx4 v3, s[20:23], s50 offen offset:3072 sc1 lds
    s_waitcnt vmcnt(8)
    s_barrier
    s_add_u32 m0, s48, 16384
    s_add_u32 s50, s50, 8192
    buffer_load_dwordx4 v3, s[20:23], s50 offen offset:0 sc1 lds
    buffer_load_dwordx4 v3, s[20:23], s50 offen offset:1024 sc1 lds
    buffer_load_dwordx4 v3, s[20:23], s50 offen offset:2048 sc1 lds
    buffer_load_dwordx4 v3, s[20:23], s50 offen offset:3072 sc1 lds
    s_add_u32 m0, s48, 24576
    s_add_u32 s50, s50, 8192
    buffer_load_dwordx4 v3, s[20:23], s50 offen offset:0 sc1 lds
    buffer_load_dwordx4 v3, s[20:23], s50 offen offset:1024 sc1 lds
    buffer_load_dwordx4 v3, s[20:23], s50 offen offset:2048 sc1 lds
    buffer_load_dwordx4 v3, s[20:23], s50 offen offset:3072 sc1 lds
    s_waitcnt vmcnt(8)
    s_barrier
    s_add_u32 m0, s48, 32768
    s_add_u32 s50, s50, 8192
    buffer_load_dwordx4 v3, s[20:23], s50 offen offset:0 sc1 lds
    buffer_load_dwordx4 v3, s[20:23], s50 offen offset:1024 sc1 lds
    buffer_load_dwordx4 v3, s[20:23], s50 offen offset:2048 sc1 lds
    buffer_load_dwordx4 v3, s[20:23], s50 offen offset:3072 sc1 lds
    s_add_u32 m0, s48, 40960
    s_add_u32 s50, s50, 8192
    buffer_load_dwordx4 v3, s[20:23], s50 offen offset:0 sc1 lds
    buffer_load_dwordx4 v3, s[20:23], s50 offen offset:1024 sc1 lds
    buffer_load_dwordx4 v3, s[20:23], s50 offen offset:2048 sc1 lds
    buffer_load_dwordx4 v3, s[20:23], s50 offen offset:3072 sc1 lds
    s_waitcnt vmcnt(8)
    s_barrier
    s_add_u32 m0, s48, 0
    s_add_u32 s50, s50, 8192
    buffer_load_dwordx4 v3, s[20:23], s50 offen offset:0 sc1 lds
    buffer_load_dwordx4 v3, s[20:23], s50 offen offset:1024 sc1 lds
    buffer_load_dwordx4 v3, s[20:23], s50 offen offset:2048 sc1 lds
    buffer_load_dwordx4 v3, s[20:23], s50 offen offset:3072 sc1 lds
    s_add_u32 m0, s48, 8192
    s_add_u32 s50, s50, 8192
    buffer_load_dwordx4 v3, s[20:23], s50 offen offset:0 sc1 lds
    buffer_load_dwordx4 v3, s[20:23], s50 offen offset:1024 sc1 lds
    buffer_load_dwordx4 v3, s[20:23], s50 offen offset:2048 sc1 lds
    buffer_load_dwordx4 v3, s[20:23], s50 offen offset:3072 sc1 lds
    s_waitcnt vmcnt(8)
    s_barrier
    s_add_u32 m0, s48, 16384
    s_add_u32 s50, s50, 8192
    buffer_load_dwordx4 v3, s[20:23], s50 offen offset:0 sc1 lds
    buffer_load_dwordx4 v3, s[20:23], s50 offen offset:1024 sc1 lds
    buffer_load_dwordx4 v3, s[20:23], s50 offen offset:2048 sc1 lds
    buffer_load_dwordx4 v3, s[20:23], s50 offen offset:3072 sc1 lds
    s_add_u32 m0, s48, 24576
    s_add_u32 s50, s50, 8192
    buffer_load_dwordx4 v3, s[20:23], s50 offen offset:0 sc1 lds
    buffer_load_dwordx4 v3, s[20:23], s50 offen offset:1024 sc1 lds
    buffer_load_dwordx4 v3, s[20:23], s50 offen offset:2048 sc1 lds
    buffer_load_dwordx4 v3, s[20:23], s50 offen offset:3072 sc1 lds
    s_waitcnt vmcnt(8)
    s_barrier
    s_waitcnt vmcnt(0)
    s_barrier
sequential_preLN__softmax_full_mha__geglu_ffn__prompt_kernel_ra_p5:
    s_barrier
    s_barrier
    s_add_u32 m0, s52, 0
    s_nop 0
    buffer_load_dwordx4 v3, s[16:19], s53 offen offset:0 sc1 lds
    buffer_load_dwordx4 v3, s[16:19], s53 offen offset:1024 sc1 lds
    buffer_load_dwordx4 v3, s[16:19], s53 offen offset:2048 sc1 lds
    buffer_load_dwordx4 v3, s[16:19], s53 offen offset:3072 sc1 lds
    s_add_u32 m0, s52, 8192
    s_add_u32 s53, s53, 8192
    buffer_load_dwordx4 v3, s[16:19], s53 offen offset:0 sc1 lds
    buffer_load_dwordx4 v3, s[16:19], s53 offen offset:1024 sc1 lds
    buffer_load_dwordx4 v3, s[16:19], s53 offen offset:2048 sc1 lds
    buffer_load_dwordx4 v3, s[16:19], s53 offen offset:3072 sc1 lds
    s_add_u32 m0, s52, 16384
    s_add_u32 s53, s53, 8192
    buffer_load_dwordx4 v3, s[16:19], s53 offen offset:0 sc1 lds
    buffer_load_dwordx4 v3, s[16:19], s53 offen offset:1024 sc1 lds
    buffer_load_dwordx4 v3, s[16:19], s53 offen offset:2048 sc1 lds
    buffer_load_dwordx4 v3, s[16:19], s53 offen offset:3072 sc1 lds
    s_add_u32 m0, s52, 24576
    s_add_u32 s53, s53, 8192
    buffer_load_dwordx4 v3, s[16:19], s53 offen offset:0 sc1 lds
    buffer_load_dwordx4 v3, s[16:19], s53 offen offset:1024 sc1 lds
    buffer_load_dwordx4 v3, s[16:19], s53 offen offset:2048 sc1 lds
    buffer_load_dwordx4 v3, s[16:19], s53 offen offset:3072 sc1 lds
    s_add_u32 m0, s52, 73728
    s_add_u32 s53, s53, 8192
    buffer_load_dwordx4 v3, s[16:19], s53 offen offset:0 sc1 lds
    buffer_load_dwordx4 v3, s[16:19], s53 offen offset:1024 sc1 lds
    buffer_load_dwordx4 v3, s[16:19], s53 offen offset:2048 sc1 lds
    buffer_load_dwordx4 v3, s[16:19], s53 offen offset:3072 sc1 lds
    s_waitcnt vmcnt(16)
    s_barrier
    s_add_u32 m0, s52, 81920
    s_add_u32 s53, s53, 8192
    buffer_load_dwordx4 v3, s[16:19], s53 offen offset:0 sc1 lds
    buffer_load_dwordx4 v3, s[16:19], s53 offen offset:1024 sc1 lds
    buffer_load_dwordx4 v3, s[16:19], s53 offen offset:2048 sc1 lds
    buffer_load_dwordx4 v3, s[16:19], s53 offen offset:3072 sc1 lds
    s_waitcnt vmcnt(16)
    s_barrier
    s_add_u32 m0, s52, 90112
    s_add_u32 s53, s53, 8192
    buffer_load_dwordx4 v3, s[16:19], s53 offen offset:0 sc1 lds
    buffer_load_dwordx4 v3, s[16:19], s53 offen offset:1024 sc1 lds
    buffer_load_dwordx4 v3, s[16:19], s53 offen offset:2048 sc1 lds
    buffer_load_dwordx4 v3, s[16:19], s53 offen offset:3072 sc1 lds
    s_waitcnt vmcnt(16)
    s_barrier
    s_add_u32 m0, s52, 98304
    s_add_u32 s53, s53, 8192
    buffer_load_dwordx4 v3, s[16:19], s53 offen offset:0 sc1 lds
    buffer_load_dwordx4 v3, s[16:19], s53 offen offset:1024 sc1 lds
    buffer_load_dwordx4 v3, s[16:19], s53 offen offset:2048 sc1 lds
    buffer_load_dwordx4 v3, s[16:19], s53 offen offset:3072 sc1 lds
    s_waitcnt vmcnt(16)
    s_barrier
    s_add_u32 m0, s52, 0
    s_add_u32 s53, s53, 8192
    buffer_load_dwordx4 v3, s[16:19], s53 offen offset:0 sc1 lds
    buffer_load_dwordx4 v3, s[16:19], s53 offen offset:1024 sc1 lds
    buffer_load_dwordx4 v3, s[16:19], s53 offen offset:2048 sc1 lds
    buffer_load_dwordx4 v3, s[16:19], s53 offen offset:3072 sc1 lds
    s_waitcnt vmcnt(16)
    s_barrier
    s_add_u32 m0, s52, 8192
    s_add_u32 s53, s53, 8192
    buffer_load_dwordx4 v3, s[16:19], s53 offen offset:0 sc1 lds
    buffer_load_dwordx4 v3, s[16:19], s53 offen offset:1024 sc1 lds
    buffer_load_dwordx4 v3, s[16:19], s53 offen offset:2048 sc1 lds
    buffer_load_dwordx4 v3, s[16:19], s53 offen offset:3072 sc1 lds
    s_waitcnt vmcnt(16)
    s_barrier
    s_add_u32 m0, s52, 16384
    s_add_u32 s53, s53, 8192
    buffer_load_dwordx4 v3, s[16:19], s53 offen offset:0 sc1 lds
    buffer_load_dwordx4 v3, s[16:19], s53 offen offset:1024 sc1 lds
    buffer_load_dwordx4 v3, s[16:19], s53 offen offset:2048 sc1 lds
    buffer_load_dwordx4 v3, s[16:19], s53 offen offset:3072 sc1 lds
    s_waitcnt vmcnt(16)
    s_barrier
    s_add_u32 m0, s52, 24576
    s_add_u32 s53, s53, 8192
    buffer_load_dwordx4 v3, s[16:19], s53 offen offset:0 sc1 lds
    buffer_load_dwordx4 v3, s[16:19], s53 offen offset:1024 sc1 lds
    buffer_load_dwordx4 v3, s[16:19], s53 offen offset:2048 sc1 lds
    buffer_load_dwordx4 v3, s[16:19], s53 offen offset:3072 sc1 lds
    s_waitcnt vmcnt(16)
    s_barrier
    s_add_u32 m0, s52, 73728
    s_add_u32 s53, s53, 8192
    buffer_load_dwordx4 v3, s[16:19], s53 offen offset:0 sc1 lds
    buffer_load_dwordx4 v3, s[16:19], s53 offen offset:1024 sc1 lds
    buffer_load_dwordx4 v3, s[16:19], s53 offen offset:2048 sc1 lds
    buffer_load_dwordx4 v3, s[16:19], s53 offen offset:3072 sc1 lds
    s_waitcnt vmcnt(16)
    s_barrier
    s_add_u32 m0, s52, 81920
    s_add_u32 s53, s53, 8192
    buffer_load_dwordx4 v3, s[16:19], s53 offen offset:0 sc1 lds
    buffer_load_dwordx4 v3, s[16:19], s53 offen offset:1024 sc1 lds
    buffer_load_dwordx4 v3, s[16:19], s53 offen offset:2048 sc1 lds
    buffer_load_dwordx4 v3, s[16:19], s53 offen offset:3072 sc1 lds
    s_waitcnt vmcnt(16)
    s_barrier
    s_add_u32 m0, s52, 90112
    s_add_u32 s53, s53, 8192
    buffer_load_dwordx4 v3, s[16:19], s53 offen offset:0 sc1 lds
    buffer_load_dwordx4 v3, s[16:19], s53 offen offset:1024 sc1 lds
    buffer_load_dwordx4 v3, s[16:19], s53 offen offset:2048 sc1 lds
    buffer_load_dwordx4 v3, s[16:19], s53 offen offset:3072 sc1 lds
    s_waitcnt vmcnt(16)
    s_barrier
    s_add_u32 m0, s52, 98304
    s_add_u32 s53, s53, 8192
    buffer_load_dwordx4 v3, s[16:19], s53 offen offset:0 sc1 lds
    buffer_load_dwordx4 v3, s[16:19], s53 offen offset:1024 sc1 lds
    buffer_load_dwordx4 v3, s[16:19], s53 offen offset:2048 sc1 lds
    buffer_load_dwordx4 v3, s[16:19], s53 offen offset:3072 sc1 lds
    s_waitcnt vmcnt(16)
    s_barrier
    s_add_u32 m0, s52, 0
    s_add_u32 s53, s53, 8192
    buffer_load_dwordx4 v3, s[16:19], s53 offen offset:0 sc1 lds
    buffer_load_dwordx4 v3, s[16:19], s53 offen offset:1024 sc1 lds
    buffer_load_dwordx4 v3, s[16:19], s53 offen offset:2048 sc1 lds
    buffer_load_dwordx4 v3, s[16:19], s53 offen offset:3072 sc1 lds
    s_waitcnt vmcnt(16)
    s_barrier
    s_add_u32 m0, s52, 8192
    s_add_u32 s53, s53, 8192
    buffer_load_dwordx4 v3, s[16:19], s53 offen offset:0 sc1 lds
    buffer_load_dwordx4 v3, s[16:19], s53 offen offset:1024 sc1 lds
    buffer_load_dwordx4 v3, s[16:19], s53 offen offset:2048 sc1 lds
    buffer_load_dwordx4 v3, s[16:19], s53 offen offset:3072 sc1 lds
    s_waitcnt vmcnt(16)
    s_barrier
    s_add_u32 m0, s52, 16384
    s_add_u32 s53, s53, 8192
    buffer_load_dwordx4 v3, s[16:19], s53 offen offset:0 sc1 lds
    buffer_load_dwordx4 v3, s[16:19], s53 offen offset:1024 sc1 lds
    buffer_load_dwordx4 v3, s[16:19], s53 offen offset:2048 sc1 lds
    buffer_load_dwordx4 v3, s[16:19], s53 offen offset:3072 sc1 lds
    s_waitcnt vmcnt(16)
    s_barrier
    s_add_u32 m0, s52, 24576
    s_add_u32 s53, s53, 8192
    buffer_load_dwordx4 v3, s[16:19], s53 offen offset:0 sc1 lds
    buffer_load_dwordx4 v3, s[16:19], s53 offen offset:1024 sc1 lds
    buffer_load_dwordx4 v3, s[16:19], s53 offen offset:2048 sc1 lds
    buffer_load_dwordx4 v3, s[16:19], s53 offen offset:3072 sc1 lds
    s_waitcnt vmcnt(16)
    s_barrier
    s_add_u32 m0, s52, 73728
    s_add_u32 s53, s53, 8192
    buffer_load_dwordx4 v3, s[16:19], s53 offen offset:0 sc1 lds
    buffer_load_dwordx4 v3, s[16:19], s53 offen offset:1024 sc1 lds
    buffer_load_dwordx4 v3, s[16:19], s53 offen offset:2048 sc1 lds
    buffer_load_dwordx4 v3, s[16:19], s53 offen offset:3072 sc1 lds
    s_waitcnt vmcnt(16)
    s_barrier
    s_add_u32 m0, s52, 81920
    s_add_u32 s53, s53, 8192
    buffer_load_dwordx4 v3, s[16:19], s53 offen offset:0 sc1 lds
    buffer_load_dwordx4 v3, s[16:19], s53 offen offset:1024 sc1 lds
    buffer_load_dwordx4 v3, s[16:19], s53 offen offset:2048 sc1 lds
    buffer_load_dwordx4 v3, s[16:19], s53 offen offset:3072 sc1 lds
    s_waitcnt vmcnt(16)
    s_barrier
    s_waitcnt vmcnt(12)
    s_barrier
    s_waitcnt vmcnt(8)
    s_barrier
    s_waitcnt vmcnt(4)
    s_barrier
    s_waitcnt vmcnt(0)
    s_barrier
    s_branch sequential_preLN__softmax_full_mha__geglu_ffn__prompt_kernel_fin
sequential_preLN__softmax_full_mha__geglu_ffn__prompt_kernel_ra_empty:
    s_barrier
    s_barrier
    s_branch sequential_preLN__softmax_full_mha__geglu_ffn__prompt_kernel_ra_p5
.p2align 12
sequential_preLN__softmax_full_mha__geglu_ffn__prompt_kernel_pg_rw:
sequential_preLN__softmax_full_mha__geglu_ffn__prompt_kernel_role_w:
    s_mov_b64 s[16:17], s[76:77]
    s_mov_b32 s18, 0x158000
    s_mov_b32 s19, 0x00020000
    s_and_b32 s52, s24, 1
    s_lshl_b32 s53, s52, 15
    s_lshl_b32 s52, s52, 12
    s_lshr_b32 s54, s2, 5
    s_lshl_b32 s54, s54, 7
    s_add_u32 s53, s53, s54
    s_barrier
    s_add_u32 s62, s57, 0x20000
    v_add_u32 v2, s62, v3
    ds_write_b128 v2, v[24:27] offset:24576
    ds_write_b128 v2, v[28:31] offset:25600
    s_add_u32 s62, s57, 0x10000
    v_add_u32 v2, s62, v3
    ds_write_b128 v2, v[32:35] offset:0
    ds_write_b128 v2, v[36:39] offset:1024
    ds_write_b128 v2, v[40:43] offset:8192
    ds_write_b128 v2, v[44:47] offset:9216
    ds_write_b128 v2, v[48:51] offset:16384
    ds_write_b128 v2, v[52:55] offset:17408
    ds_write_b128 v2, v[56:59] offset:24576
    ds_write_b128 v2, v[60:63] offset:25600
    ds_write_b128 v2, v[64:67] offset:32768
    ds_write_b128 v2, v[68:71] offset:33792
    v_add_f32 v144, v144, v145
    v_add_f32 v144, v144, v146
    v_add_f32 v144, v144, v147
    v_add_f32 v144, v144, v148
    v_add_f32 v144, v144, v149
    v_add_f32 v144, v144, v150
    v_add_f32 v144, v144, v151
    v_add_f32 v144, v144, v152
    v_add_f32 v144, v144, v153
    v_add_f32 v144, v144, v154
    v_add_f32 v144, v144, v155
    v_add_f32 v144, v144, v156
    v_add_f32 v144, v144, v157
    v_add_f32 v144, v144, v158
    v_add_f32 v144, v144, v159
    v_cvt_pk_bf16_f32 v145, v144, v144
    v_lshlrev_b32 v145, 16, v145
    v_sub_f32 v145, v144, v145
    v_cvt_pk_bf16_f32 v20, v144, v145
    s_barrier
    s_barrier
    s_waitcnt lgkmcnt(0)
    s_barrier
    s_barrier
    s_barrier
    s_barrier
    s_barrier
    s_barrier
    s_barrier
    s_barrier
    s_cmp_ge_u32 s47, 15
    s_cbranch_scc1 sequential_preLN__softmax_full_mha__geglu_ffn__prompt_kernel_rw_empty
    s_barrier
    s_add_u32 s62, s59, 0x10000
    v_add_u32 v1, s62, v3
    ds_write_b128 v1, v[72:75] offset:40960
    ds_write_b128 v1, v[76:79] offset:41984
    ds_write_b128 v1, v[80:83] offset:43008
    ds_write_b128 v1, v[84:87] offset:53248
    ds_write_b128 v1, v[88:91] offset:54272
    ds_write_b128 v1, v[92:95] offset:55296
    s_barrier
    s_add_u32 s62, s59, 0x0
    v_add_u32 v1, s62, v3
    ds_write_b128 v1, v[120:123] offset:49152
    ds_write_b128 v1, v[124:127] offset:50176
    ds_write_b128 v1, v[128:131] offset:51200
    ds_write_b128 v1, v[132:135] offset:61440
    ds_write_b128 v1, v[136:139] offset:62464
    ds_write_b128 v1, v[140:143] offset:63488
    s_add_u32 s62, s59, 0x20000
    v_add_u32 v1, s62, v3
    ds_write_b128 v1, v[96:99] offset:0
    ds_write_b128 v1, v[100:103] offset:1024
    ds_write_b128 v1, v[104:107] offset:2048
    ds_write_b128 v1, v[108:111] offset:12288
    ds_write_b128 v1, v[112:115] offset:13312
    ds_write_b128 v1, v[116:119] offset:14336
    ds_write_b32 v21, v20
    s_waitcnt lgkmcnt(0)
    s_barrier
    s_barrier
    s_add_u32 m0, s48, 73728
    s_add_u32 s50, s50, 12288
    buffer_load_dwordx4 v3, s[20:23], s50 offen offset:0 sc1 lds
    buffer_load_dwordx4 v3, s[20:23], s50 offen offset:1024 sc1 lds
    buffer_load_dwordx4 v3, s[20:23], s50 offen offset:2048 sc1 lds
    buffer_load_dwordx4 v3, s[20:23], s50 offen offset:3072 sc1 lds
    s_add_u32 m0, m0, 4096
    s_add_u32 s51, s50, 4096
    buffer_load_dwordx4 v3, s[20:23], s51 offen offset:0 sc1 lds
    buffer_load_dwordx4 v3, s[20:23], s51 offen offset:1024 sc1 lds
    s_barrier
    s_add_u32 m0, s48, 86016
    s_add_u32 s50, s50, 12288
    buffer_load_dwordx4 v3, s[20:23], s50 offen offset:0 sc1 lds
    buffer_load_dwordx4 v3, s[20:23], s50 offen offset:1024 sc1 lds
    buffer_load_dwordx4 v3, s[20:23], s50 offen offset:2048 sc1 lds
    buffer_load_dwordx4 v3, s[20:23], s50 offen offset:3072 sc1 lds
    s_add_u32 m0, m0, 4096
    s_add_u32 s51, s50, 4096
    buffer_load_dwordx4 v3, s[20:23], s51 offen offset:0 sc1 lds
    buffer_load_dwordx4 v3, s[20:23], s51 offen offset:1024 sc1 lds
    s_barrier
    s_add_u32 m0, s48, 106496
    s_add_u32 s50, s50, 12288
    buffer_load_dwordx4 v3, s[20:23], s50 offen offset:0 sc1 lds
    buffer_load_dwordx4 v3, s[20:23], s50 offen offset:1024 sc1 lds
    buffer_load_dwordx4 v3, s[20:23], s50 offen offset:2048 sc1 lds
    buffer_load_dwordx4 v3, s[20:23], s50 offen offset:3072 sc1 lds
    s_add_u32 m0, m0, 4096
    s_add_u32 s51, s50, 4096
    buffer_load_dwordx4 v3, s[20:23], s51 offen offset:0 sc1 lds
    buffer_load_dwordx4 v3, s[20:23], s51 offen offset:1024 sc1 lds
    s_add_u32 m0, s48, 118784
    s_add_u32 s50, s50, 12288
    buffer_load_dwordx4 v3, s[20:23], s50 offen offset:0 sc1 lds
    buffer_load_dwordx4 v3, s[20:23], s50 offen offset:1024 sc1 lds
    buffer_load_dwordx4 v3, s[20:23], s50 offen offset:2048 sc1 lds
    buffer_load_dwordx4 v3, s[20:23], s50 offen offset:3072 sc1 lds
    s_add_u32 m0, m0, 4096
    s_add_u32 s51, s50, 4096
    buffer_load_dwordx4 v3, s[20:23], s51 offen offset:0 sc1 lds
    buffer_load_dwordx4 v3, s[20:23], s51 offen offset:1024 sc1 lds
    s_barrier
    s_add_u32 m0, s48, 131072
    s_add_u32 s50, s50, 12288
    buffer_load_dwordx4 v3, s[20:23], s50 offen offset:0 sc1 lds
    buffer_load_dwordx4 v3, s[20:23], s50 offen offset:1024 sc1 lds
    buffer_load_dwordx4 v3, s[20:23], s50 offen offset:2048 sc1 lds
    buffer_load_dwordx4 v3, s[20:23], s50 offen offset:3072 sc1 lds
    s_add_u32 m0, m0, 4096
    s_add_u32 s51, s50, 4096
    buffer_load_dwordx4 v3, s[20:23], s51 offen offset:0 sc1 lds
    buffer_load_dwordx4 v3, s[20:23], s51 offen offset:1024 sc1 lds
    s_add_u32 m0, s48, 143360
    s_add_u32 s50, s50, 12288
    buffer_load_dwordx4 v3, s[20:23], s50 offen offset:0 sc1 lds
    buffer_load_dwordx4 v3, s[20:23], s50 offen offset:1024 sc1 lds
    buffer_load_dwordx4 v3, s[20:23], s50 offen offset:2048 sc1 lds
    buffer_load_dwordx4 v3, s[20:23], s50 offen offset:3072 sc1 lds
    s_add_u32 m0, m0, 4096
    s_add_u32 s51, s50, 4096
    buffer_load_dwordx4 v3, s[20:23], s51 offen offset:0 sc1 lds
    buffer_load_dwordx4 v3, s[20:23], s51 offen offset:1024 sc1 lds
    s_waitcnt vmcnt(24)
    s_barrier
    s_add_u32 m0, s48, 49152
    s_add_u32 s50, s50, 12288
    buffer_load_dwordx4 v3, s[20:23], s50 offen offset:0 sc1 lds
    buffer_load_dwordx4 v3, s[20:23], s50 offen offset:1024 sc1 lds
    buffer_load_dwordx4 v3, s[20:23], s50 offen offset:2048 sc1 lds
    buffer_load_dwordx4 v3, s[20:23], s50 offen offset:3072 sc1 lds
    s_add_u32 m0, m0, 4096
    s_add_u32 s51, s50, 4096
    buffer_load_dwordx4 v3, s[20:23], s51 offen offset:0 sc1 lds
    buffer_load_dwordx4 v3, s[20:23], s51 offen offset:1024 sc1 lds
    s_add_u32 m0, s48, 61440
    s_add_u32 s50, s50, 12288
    buffer_load_dwordx4 v3, s[20:23], s50 offen offset:0 sc1 lds
    buffer_load_dwordx4 v3, s[20:23], s50 offen offset:1024 sc1 lds
    buffer_load_dwordx4 v3, s[20:23], s50 offen offset:2048 sc1 lds
    buffer_load_dwordx4 v3, s[20:23], s50 offen offset:3072 sc1 lds
    s_add_u32 m0, m0, 4096
    s_add_u32 s51, s50, 4096
    buffer_load_dwordx4 v3, s[20:23], s51 offen offset:0 sc1 lds
    buffer_load_dwordx4 v3, s[20:23], s51 offen offset:1024 sc1 lds
    s_waitcnt vmcnt(24)
    s_barrier
    s_add_u32 m0, s48, 73728
    s_add_u32 s50, s50, 12288
    buffer_load_dwordx4 v3, s[20:23], s50 offen offset:0 sc1 lds
    buffer_load_dwordx4 v3, s[20:23], s50 offen offset:1024 sc1 lds
    buffer_load_dwordx4 v3, s[20:23], s50 offen offset:2048 sc1 lds
    buffer_load_dwordx4 v3, s[20:23], s50 offen offset:3072 sc1 lds
    s_add_u32 m0, m0, 4096
    s_add_u32 s51, s50, 4096
    buffer_load_dwordx4 v3, s[20:23], s51 offen offset:0 sc1 lds
    buffer_load_dwordx4 v3, s[20:23], s51 offen offset:1024 sc1 lds
    s_add_u32 m0, s48, 86016
    s_add_u32 s50, s50, 12288
    buffer_load_dwordx4 v3, s[20:23], s50 offen offset:0 sc1 lds
    buffer_load_dwordx4 v3, s[20:23], s50 offen offset:1024 sc1 lds
    buffer_load_dwordx4 v3, s[20:23], s50 offen offset:2048 sc1 lds
    buffer_load_dwordx4 v3, s[20:23], s50 offen offset:3072 sc1 lds
    s_add_u32 m0, m0, 4096
    s_add_u32 s51, s50, 4096
    buffer_load_dwordx4 v3, s[20:23], s51 offen offset:0 sc1 lds
    buffer_load_dwordx4 v3, s[20:23], s51 offen offset:1024 sc1 lds
    s_add_u32 m0, s52, 155648
    s_add_u32 s54, s53, 7168
    buffer_load_dwordx4 v22, s[16:19], s53 offen lds
    s_add_u32 s55, s53, 14336
    buffer_load_dwordx4 v22, s[16:19], s54 offen offset:1024 lds
    s_add_u32 s54, s53, 21504
    buffer_load_dwordx4 v22, s[16:19], s55 offen offset:2048 lds
    s_add_u32 s53, s53, 0x10000
    buffer_load_dwordx4 v22, s[16:19], s54 offen offset:3072 lds
    s_waitcnt vmcnt(28)
    s_barrier
    s_add_u32 m0, s52, 106496
    s_add_u32 s54, s53, 7168
    buffer_load_dwordx4 v22, s[16:19], s53 offen lds
    s_add_u32 s55, s53, 14336
    buffer_load_dwordx4 v22, s[16:19], s54 offen offset:1024 lds
    s_add_u32 s54, s53, 21504
    buffer_load_dwordx4 v22, s[16:19], s55 offen offset:2048 lds
    s_add_u32 s53, s53, 0x10000
    buffer_load_dwordx4 v22, s[16:19], s54 offen offset:3072 lds
    s_add_u32 m0, s52, 114688
    s_add_u32 s54, s53, 7168
    buffer_load_dwordx4 v22, s[16:19], s53 offen lds
    s_add_u32 s55, s53, 14336
    buffer_load_dwordx4 v22, s[16:19], s54 offen offset:1024 lds
    s_add_u32 s54, s53, 21504
    buffer_load_dwordx4 v22, s[16:19], s55 offen offset:2048 lds
    s_add_u32 s53, s53, 0x10000
    buffer_load_dwordx4 v22, s[16:19], s54 offen offset:3072 lds
    s_add_u32 m0, s52, 122880
    s_add_u32 s54, s53, 7168
    buffer_load_dwordx4 v22, s[16:19], s53 offen lds
    s_add_u32 s55, s53, 14336
    buffer_load_dwordx4 v22, s[16:19], s54 offen offset:1024 lds
    s_add_u32 s54, s53, 21504
    buffer_load_dwordx4 v22, s[16:19], s55 offen offset:2048 lds
    s_add_u32 s53, s53, 0x10000
    buffer_load_dwordx4 v22, s[16:19], s54 offen offset:3072 lds
    s_waitcnt vmcnt(28)
    s_barrier
    s_add_u32 m0, s52, 131072
    s_add_u32 s54, s53, 7168
    buffer_load_dwordx4 v22, s[16:19], s53 offen lds
    s_add_u32 s55, s53, 14336
    buffer_load_dwordx4 v22, s[16:19], s54 offen offset:1024 lds
    s_add_u32 s54, s53, 21504
    buffer_load_dwordx4 v22, s[16:19], s55 offen offset:2048 lds
    s_add_u32 s53, s53, 0x10000
    buffer_load_dwordx4 v22, s[16:19], s54 offen offset:3072 lds
    s_add_u32 m0, s52, 139264
    s_add_u32 s54, s53, 7168
    buffer_load_dwordx4 v22, s[16:19], s53 offen lds
    s_add_u32 s55, s53, 14336
    buffer_load_dwordx4 v22, s[16:19], s54 offen offset:1024 lds
    s_add_u32 s54, s53, 21504
    buffer_load_dwordx4 v22, s[16:19], s55 offen offset:2048 lds
    s_add_u32 s53, s53, 0x10000
    buffer_load_dwordx4 v22, s[16:19], s54 offen offset:3072 lds
    s_add_u32 m0, s52, 147456
    s_add_u32 s54, s53, 7168
    buffer_load_dwordx4 v22, s[16:19], s53 offen lds
    s_add_u32 s55, s53, 14336
    buffer_load_dwordx4 v22, s[16:19], s54 offen offset:1024 lds
    s_add_u32 s54, s53, 21504
    buffer_load_dwordx4 v22, s[16:19], s55 offen offset:2048 lds
    s_add_u32 s53, s53, 0x10000
    buffer_load_dwordx4 v22, s[16:19], s54 offen offset:3072 lds
    s_add_u32 m0, s52, 32768
    s_add_u32 s54, s53, 7168
    buffer_load_dwordx4 v22, s[16:19], s53 offen lds
    s_add_u32 s55, s53, 14336
    buffer_load_dwordx4 v22, s[16:19], s54 offen offset:1024 lds
    s_add_u32 s54, s53, 21504
    buffer_load_dwordx4 v22, s[16:19], s55 offen offset:2048 lds
    s_add_u32 s53, s53, 0x10000
    buffer_load_dwordx4 v22, s[16:19], s54 offen offset:3072 lds
    s_add_u32 m0, s52, 40960
    s_add_u32 s54, s53, 7168
    buffer_load_dwordx4 v22, s[16:19], s53 offen lds
    s_add_u32 s55, s53, 14336
    buffer_load_dwordx4 v22, s[16:19], s54 offen offset:1024 lds
    s_add_u32 s54, s53, 21504
    buffer_load_dwordx4 v22, s[16:19], s55 offen offset:2048 lds
    s_add_u32 s53, s53, 0x10000
    buffer_load_dwordx4 v22, s[16:19], s54 offen offset:3072 lds
    s_waitcnt vmcnt(36)
    s_barrier
    s_add_u32 m0, s52, 49152
    s_add_u32 s54, s53, 7168
    buffer_load_dwordx4 v22, s[16:19], s53 offen lds
    s_add_u32 s55, s53, 14336
    buffer_load_dwordx4 v22, s[16:19], s54 offen offset:1024 lds
    s_add_u32 s54, s53, 21504
    buffer_load_dwordx4 v22, s[16:19], s55 offen offset:2048 lds
    s_add_u32 s53, s53, 0x10000
    buffer_load_dwordx4 v22, s[16:19], s54 offen offset:3072 lds
    s_add_u32 m0, s52, 57344
    s_add_u32 s54, s53, 7168
    buffer_load_dwordx4 v22, s[16:19], s53 offen lds
    s_add_u32 s55, s53, 14336
    buffer_load_dwordx4 v22, s[16:19], s54 offen offset:1024 lds
    s_add_u32 s54, s53, 21504
    buffer_load_dwordx4 v22, s[16:19], s55 offen offset:2048 lds
    s_add_u32 s53, s53, 0x10000
    buffer_load_dwordx4 v22, s[16:19], s54 offen offset:3072 lds
    s_add_u32 m0, s52, 65536
    s_add_u32 s54, s53, 7168
    buffer_load_dwordx4 v22, s[16:19], s53 offen lds
    s_add_u32 s55, s53, 14336
    buffer_load_dwordx4 v22, s[16:19], s54 offen offset:1024 lds
    s_add_u32 s54, s53, 21504
    buffer_load_dwordx4 v22, s[16:19], s55 offen offset:2048 lds
    s_add_u32 s53, s53, 0x10000
    buffer_load_dwordx4 v22, s[16:19], s54 offen offset:3072 lds
sequential_preLN__softmax_full_mha__geglu_ffn__prompt_kernel_rw_p5:
    s_barrier
    s_barrier
    s_waitcnt vmcnt(44)
    s_barrier
    s_waitcnt vmcnt(40)
    s_barrier
    s_waitcnt vmcnt(36)
    s_barrier
    s_add_u32 m0, s52, 155648
    s_add_u32 s54, s53, 7168
    buffer_load_dwordx4 v22, s[16:19], s53 offen lds
    s_add_u32 s55, s53, 14336
    buffer_load_dwordx4 v22, s[16:19], s54 offen offset:1024 lds
    s_add_u32 s54, s53, 21504
    buffer_load_dwordx4 v22, s[16:19], s55 offen offset:2048 lds
    s_add_u32 s53, s53, 0x10000
    buffer_load_dwordx4 v22, s[16:19], s54 offen offset:3072 lds
    s_waitcnt vmcnt(36)
    s_barrier
    s_add_u32 m0, s52, 106496
    s_add_u32 s54, s53, 7168
    buffer_load_dwordx4 v22, s[16:19], s53 offen lds
    s_add_u32 s55, s53, 14336
    buffer_load_dwordx4 v22, s[16:19], s54 offen offset:1024 lds
    s_add_u32 s54, s53, 21504
    buffer_load_dwordx4 v22, s[16:19], s55 offen offset:2048 lds
    s_add_u32 s53, s53, 0x10000
    buffer_load_dwordx4 v22, s[16:19], s54 offen offset:3072 lds
    s_waitcnt vmcnt(36)
    s_barrier
    s_add_u32 m0, s52, 114688
    s_add_u32 s54, s53, 7168
    buffer_load_dwordx4 v22, s[16:19], s53 offen lds
    s_add_u32 s55, s53, 14336
    buffer_load_dwordx4 v22, s[16:19], s54 offen offset:1024 lds
    s_add_u32 s54, s53, 21504
    buffer_load_dwordx4 v22, s[16:19], s55 offen offset:2048 lds
    s_add_u32 s53, s53, 0x10000
    buffer_load_dwordx4 v22, s[16:19], s54 offen offset:3072 lds
    s_waitcnt vmcnt(36)
    s_barrier
    s_add_u32 m0, s52, 122880
    s_add_u32 s54, s53, 7168
    buffer_load_dwordx4 v22, s[16:19], s53 offen lds
    s_add_u32 s55, s53, 14336
    buffer_load_dwordx4 v22, s[16:19], s54 offen offset:1024 lds
    s_add_u32 s54, s53, 21504
    buffer_load_dwordx4 v22, s[16:19], s55 offen offset:2048 lds
    s_add_u32 s53, s53, 0x10000
    buffer_load_dwordx4 v22, s[16:19], s54 offen offset:3072 lds
    s_waitcnt vmcnt(36)
    s_barrier
    s_add_u32 m0, s52, 131072
    s_add_u32 s54, s53, 7168
    buffer_load_dwordx4 v22, s[16:19], s53 offen lds
    s_add_u32 s55, s53, 14336
    buffer_load_dwordx4 v22, s[16:19], s54 offen offset:1024 lds
    s_add_u32 s54, s53, 21504
    buffer_load_dwordx4 v22, s[16:19], s55 offen offset:2048 lds
    s_add_u32 s53, s53, 0x10000
    buffer_load_dwordx4 v22, s[16:19], s54 offen offset:3072 lds
    s_waitcnt vmcnt(36)
    s_barrier
    s_add_u32 m0, s52, 139264
    s_add_u32 s54, s53, 7168
    buffer_load_dwordx4 v22, s[16:19], s53 offen lds
    s_add_u32 s55, s53, 14336
    buffer_load_dwordx4 v22, s[16:19], s54 offen offset:1024 lds
    s_add_u32 s54, s53, 21504
    buffer_load_dwordx4 v22, s[16:19], s55 offen offset:2048 lds
    s_add_u32 s53, s53, 0x10000
    buffer_load_dwordx4 v22, s[16:19], s54 offen offset:3072 lds
    s_waitcnt vmcnt(36)
    s_barrier
    s_add_u32 m0, s52, 147456
    s_add_u32 s54, s53, 7168
    buffer_load_dwordx4 v22, s[16:19], s53 offen lds
    s_add_u32 s55, s53, 14336
    buffer_load_dwordx4 v22, s[16:19], s54 offen offset:1024 lds
    s_add_u32 s54, s53, 21504
    buffer_load_dwordx4 v22, s[16:19], s55 offen offset:2048 lds
    s_add_u32 s53, s53, 0x10000
    buffer_load_dwordx4 v22, s[16:19], s54 offen offset:3072 lds
    s_waitcnt vmcnt(36)
    s_barrier
    s_add_u32 m0, s52, 32768
    s_add_u32 s54, s53, 7168
    buffer_load_dwordx4 v22, s[16:19], s53 offen lds
    s_add_u32 s55, s53, 14336
    buffer_load_dwordx4 v22, s[16:19], s54 offen offset:1024 lds
    s_add_u32 s54, s53, 21504
    buffer_load_dwordx4 v22, s[16:19], s55 offen offset:2048 lds
    s_add_u32 s53, s53, 0x10000
    buffer_load_dwordx4 v22, s[16:19], s54 offen offset:3072 lds
    s_waitcnt vmcnt(36)
    s_barrier
    s_add_u32 m0, s52, 40960
    s_add_u32 s54, s53, 7168
    buffer_load_dwordx4 v22, s[16:19], s53 offen lds
    s_add_u32 s55, s53, 14336
    buffer_load_dwordx4 v22, s[16:19], s54 offen offset:1024 lds
    s_add_u32 s54, s53, 21504
    buffer_load_dwordx4 v22, s[16:19], s55 offen offset:2048 lds
    s_add_u32 s53, s53, 0x10000
    buffer_load_dwordx4 v22, s[16:19], s54 offen offset:3072 lds
    s_waitcnt vmcnt(36)
    s_barrier
    s_add_u32 m0, s52, 49152
    s_add_u32 s54, s53, 7168
    buffer_load_dwordx4 v22, s[16:19], s53 offen lds
    s_add_u32 s55, s53, 14336
    buffer_load_dwordx4 v22, s[16:19], s54 offen offset:1024 lds
    s_add_u32 s54, s53, 21504
    buffer_load_dwordx4 v22, s[16:19], s55 offen offset:2048 lds
    s_add_u32 s53, s53, 0x10000
    buffer_load_dwordx4 v22, s[16:19], s54 offen offset:3072 lds
    s_waitcnt vmcnt(36)
    s_barrier
    s_waitcnt vmcnt(32)
    s_barrier
    s_waitcnt vmcnt(28)
    s_barrier
    s_waitcnt vmcnt(24)
    s_barrier
    s_waitcnt vmcnt(20)
    s_barrier
    s_waitcnt vmcnt(16)
    s_barrier
    s_waitcnt vmcnt(12)
    s_barrier
    s_waitcnt vmcnt(8)
    s_barrier
    s_waitcnt vmcnt(4)
    s_barrier
    s_waitcnt vmcnt(0)
    s_barrier
    s_branch sequential_preLN__softmax_full_mha__geglu_ffn__prompt_kernel_fin
sequential_preLN__softmax_full_mha__geglu_ffn__prompt_kernel_rw_empty:
    s_barrier
    s_barrier
    s_add_u32 m0, s52, 155648
    s_add_u32 s54, s53, 7168
    buffer_load_dwordx4 v22, s[16:19], s53 offen lds
    s_add_u32 s55, s53, 14336
    buffer_load_dwordx4 v22, s[16:19], s54 offen offset:1024 lds
    s_add_u32 s54, s53, 21504
    buffer_load_dwordx4 v22, s[16:19], s55 offen offset:2048 lds
    s_add_u32 s53, s53, 0x10000
    buffer_load_dwordx4 v22, s[16:19], s54 offen offset:3072 lds
    s_add_u32 m0, s52, 106496
    s_add_u32 s54, s53, 7168
    buffer_load_dwordx4 v22, s[16:19], s53 offen lds
    s_add_u32 s55, s53, 14336
    buffer_load_dwordx4 v22, s[16:19], s54 offen offset:1024 lds
    s_add_u32 s54, s53, 21504
    buffer_load_dwordx4 v22, s[16:19], s55 offen offset:2048 lds
    s_add_u32 s53, s53, 0x10000
    buffer_load_dwordx4 v22, s[16:19], s54 offen offset:3072 lds
    s_add_u32 m0, s52, 114688
    s_add_u32 s54, s53, 7168
    buffer_load_dwordx4 v22, s[16:19], s53 offen lds
    s_add_u32 s55, s53, 14336
    buffer_load_dwordx4 v22, s[16:19], s54 offen offset:1024 lds
    s_add_u32 s54, s53, 21504
    buffer_load_dwordx4 v22, s[16:19], s55 offen offset:2048 lds
    s_add_u32 s53, s53, 0x10000
    buffer_load_dwordx4 v22, s[16:19], s54 offen offset:3072 lds
    s_add_u32 m0, s52, 122880
    s_add_u32 s54, s53, 7168
    buffer_load_dwordx4 v22, s[16:19], s53 offen lds
    s_add_u32 s55, s53, 14336
    buffer_load_dwordx4 v22, s[16:19], s54 offen offset:1024 lds
    s_add_u32 s54, s53, 21504
    buffer_load_dwordx4 v22, s[16:19], s55 offen offset:2048 lds
    s_add_u32 s53, s53, 0x10000
    buffer_load_dwordx4 v22, s[16:19], s54 offen offset:3072 lds
    s_add_u32 m0, s52, 131072
    s_add_u32 s54, s53, 7168
    buffer_load_dwordx4 v22, s[16:19], s53 offen lds
    s_add_u32 s55, s53, 14336
    buffer_load_dwordx4 v22, s[16:19], s54 offen offset:1024 lds
    s_add_u32 s54, s53, 21504
    buffer_load_dwordx4 v22, s[16:19], s55 offen offset:2048 lds
    s_add_u32 s53, s53, 0x10000
    buffer_load_dwordx4 v22, s[16:19], s54 offen offset:3072 lds
    s_add_u32 m0, s52, 139264
    s_add_u32 s54, s53, 7168
    buffer_load_dwordx4 v22, s[16:19], s53 offen lds
    s_add_u32 s55, s53, 14336
    buffer_load_dwordx4 v22, s[16:19], s54 offen offset:1024 lds
    s_add_u32 s54, s53, 21504
    buffer_load_dwordx4 v22, s[16:19], s55 offen offset:2048 lds
    s_add_u32 s53, s53, 0x10000
    buffer_load_dwordx4 v22, s[16:19], s54 offen offset:3072 lds
    s_add_u32 m0, s52, 147456
    s_add_u32 s54, s53, 7168
    buffer_load_dwordx4 v22, s[16:19], s53 offen lds
    s_add_u32 s55, s53, 14336
    buffer_load_dwordx4 v22, s[16:19], s54 offen offset:1024 lds
    s_add_u32 s54, s53, 21504
    buffer_load_dwordx4 v22, s[16:19], s55 offen offset:2048 lds
    s_add_u32 s53, s53, 0x10000
    buffer_load_dwordx4 v22, s[16:19], s54 offen offset:3072 lds
    s_add_u32 m0, s52, 32768
    s_add_u32 s54, s53, 7168
    buffer_load_dwordx4 v22, s[16:19], s53 offen lds
    s_add_u32 s55, s53, 14336
    buffer_load_dwordx4 v22, s[16:19], s54 offen offset:1024 lds
    s_add_u32 s54, s53, 21504
    buffer_load_dwordx4 v22, s[16:19], s55 offen offset:2048 lds
    s_add_u32 s53, s53, 0x10000
    buffer_load_dwordx4 v22, s[16:19], s54 offen offset:3072 lds
    s_add_u32 m0, s52, 40960
    s_add_u32 s54, s53, 7168
    buffer_load_dwordx4 v22, s[16:19], s53 offen lds
    s_add_u32 s55, s53, 14336
    buffer_load_dwordx4 v22, s[16:19], s54 offen offset:1024 lds
    s_add_u32 s54, s53, 21504
    buffer_load_dwordx4 v22, s[16:19], s55 offen offset:2048 lds
    s_add_u32 s53, s53, 0x10000
    buffer_load_dwordx4 v22, s[16:19], s54 offen offset:3072 lds
    s_add_u32 m0, s52, 49152
    s_add_u32 s54, s53, 7168
    buffer_load_dwordx4 v22, s[16:19], s53 offen lds
    s_add_u32 s55, s53, 14336
    buffer_load_dwordx4 v22, s[16:19], s54 offen offset:1024 lds
    s_add_u32 s54, s53, 21504
    buffer_load_dwordx4 v22, s[16:19], s55 offen offset:2048 lds
    s_add_u32 s53, s53, 0x10000
    buffer_load_dwordx4 v22, s[16:19], s54 offen offset:3072 lds
    s_add_u32 m0, s52, 57344
    s_add_u32 s54, s53, 7168
    buffer_load_dwordx4 v22, s[16:19], s53 offen lds
    s_add_u32 s55, s53, 14336
    buffer_load_dwordx4 v22, s[16:19], s54 offen offset:1024 lds
    s_add_u32 s54, s53, 21504
    buffer_load_dwordx4 v22, s[16:19], s55 offen offset:2048 lds
    s_add_u32 s53, s53, 0x10000
    buffer_load_dwordx4 v22, s[16:19], s54 offen offset:3072 lds
    s_add_u32 m0, s52, 65536
    s_add_u32 s54, s53, 7168
    buffer_load_dwordx4 v22, s[16:19], s53 offen lds
    s_add_u32 s55, s53, 14336
    buffer_load_dwordx4 v22, s[16:19], s54 offen offset:1024 lds
    s_add_u32 s54, s53, 21504
    buffer_load_dwordx4 v22, s[16:19], s55 offen offset:2048 lds
    s_add_u32 s53, s53, 0x10000
    buffer_load_dwordx4 v22, s[16:19], s54 offen offset:3072 lds
    s_branch sequential_preLN__softmax_full_mha__geglu_ffn__prompt_kernel_rw_p5
.p2align 12
sequential_preLN__softmax_full_mha__geglu_ffn__prompt_kernel_pg_s1:
sequential_preLN__softmax_full_mha__geglu_ffn__prompt_kernel_p1_stat:
    s_setprio 3
    s_and_b32 s29, s24, 3
    v_and_b32 v1, 15, v0
    v_lshrrev_b32 v4, 1, v1
    v_mul_u32_u24 v9, 1040, v4
    v_and_b32 v4, 1, v0
    v_lshl_add_u32 v9, v4, 9, v9
    v_lshrrev_b32 v2, 4, v0
    v_xor_b32 v2, v2, v4
    v_lshl_add_u32 v9, v2, 7, v9
    s_mul_i32 s36, s29, 8320
    v_add_u32 v9, s36, v9
    v_mov_b32 v5, 0
    v_mov_b32 v6, 0
    v_mov_b32 v7, 0
    v_mov_b32 v8, 0
    v_mov_b32 v10, 0
    s_mov_b32 s41, 0xffff0000
    s_mov_b32 s40, 0
    s_lshl_b32 s36, s29, 6
    s_add_u32 s36, s36, 148480
    v_lshl_add_u32 v1, v1, 2, s36
    v_mov_b32 v2, 148992
    s_waitcnt lgkmcnt(0)
    s_mov_b64 s[20:21], s[82:83]
    s_mov_b64 s[12:13], s[80:81]
    s_mov_b32 s14, 0x100
    s_mov_b32 s15, 0x00020000
    s_lshl_b32 s36, s2, 4
    s_add_u32 s36, s36, s24
    s_cmp_lg_u32 s36, 8
    s_cbranch_scc1 sequential_preLN__softmax_full_mha__geglu_ffn__prompt_kernel_p1_notag
    s_memrealtime s[36:37]
    s_waitcnt lgkmcnt(0)
    s_or_b32 s37, s37, 0x40000000
    v_mov_b32 v22, s36
    v_mov_b32 v23, s37
    buffer_store_dwordx2 v[22:23], v10, s[12:15], 0 offen sc1
    s_waitcnt vmcnt(0)
sequential_preLN__softmax_full_mha__geglu_ffn__prompt_kernel_p1_notag:
    s_cmp_lg_u32 s24, 9
    s_cbranch_scc1 sequential_preLN__softmax_full_mha__geglu_ffn__prompt_kernel_p1_nombw
    s_lshl_b32 s62, s2, 9
    s_add_u32 s62, s62, 0x1780000
    v_lshlrev_b32 v44, 3, v0
    v_mov_b32 v46, 0
    v_mov_b32 v47, 0
    buffer_atomic_or_x2 v[46:47], v44, s[20:23], s62 offen sc1
sequential_preLN__softmax_full_mha__geglu_ffn__prompt_kernel_p1_nombw:
    s_mov_b32 s41, 0x3f803f80
    s_lshl_b32 s59, s27, 2
    s_add_u32 s59, s59, s29
    s_mul_i32 s59, s59, 49152
    s_lshl_b32 s36, s26, 7
    s_add_u32 s59, s59, s36
    s_add_u32 s56, s66, s59
    s_addc_u32 s57, s67, 0
sequential_preLN__softmax_full_mha__geglu_ffn__prompt_kernel_p1_sloop:
    s_barrier
    ds_read_b128 v[60:63], v9 offset:0
    ds_read_b128 v[64:67], v9 offset:16
    ds_read_b128 v[68:71], v9 offset:32
    ds_read_b128 v[72:75], v9 offset:48
    ds_read_b128 v[76:79], v9 offset:64
    ds_read_b128 v[80:83], v9 offset:80
    ds_read_b128 v[84:87], v9 offset:96
    ds_read_b128 v[88:91], v9 offset:112
    v_add_u32 v9, 33280, v9
    s_add_u32 s40, s40, 1
    s_cmp_lt_u32 s40, 2
    s_waitcnt lgkmcnt(0)
    v_dot2c_f32_bf16 v7, s41, v60
    v_dot2c_f32_bf16 v8, v60, v60
    v_dot2c_f32_bf16 v5, s41, v61
    v_dot2c_f32_bf16 v6, v61, v61
    v_dot2c_f32_bf16 v7, s41, v62
    v_dot2c_f32_bf16 v8, v62, v62
    v_dot2c_f32_bf16 v5, s41, v63
    v_dot2c_f32_bf16 v6, v63, v63
    v_dot2c_f32_bf16 v7, s41, v64
    v_dot2c_f32_bf16 v8, v64, v64
    v_dot2c_f32_bf16 v5, s41, v65
    v_dot2c_f32_bf16 v6, v65, v65
    v_dot2c_f32_bf16 v7, s41, v66
    v_dot2c_f32_bf16 v8, v66, v66
    v_dot2c_f32_bf16 v5, s41, v67
    v_dot2c_f32_bf16 v6, v67, v67
    v_dot2c_f32_bf16 v7, s41, v68
    v_dot2c_f32_bf16 v8, v68, v68
    v_dot2c_f32_bf16 v5, s41, v69
    v_dot2c_f32_bf16 v6, v69, v69
    v_dot2c_f32_bf16 v7, s41, v70
    v_dot2c_f32_bf16 v8, v70, v70
    v_dot2c_f32_bf16 v5, s41, v71
    v_dot2c_f32_bf16 v6, v71, v71
    v_dot2c_f32_bf16 v7, s41, v72
    v_dot2c_f32_bf16 v8, v72, v72
    v_dot2c_f32_bf16 v5, s41, v73
    v_dot2c_f32_bf16 v6, v73, v73
    v_dot2c_f32_bf16 v7, s41, v74
    v_dot2c_f32_bf16 v8, v74, v74
    v_dot2c_f32_bf16 v5, s41, v75
    v_dot2c_f32_bf16 v6, v75, v75
    v_dot2c_f32_bf16 v7, s41, v76
    v_dot2c_f32_bf16 v8, v76, v76
    v_dot2c_f32_bf16 v5, s41, v77
    v_dot2c_f32_bf16 v6, v77, v77
    v_dot2c_f32_bf16 v7, s41, v78
    v_dot2c_f32_bf16 v8, v78, v78
    v_dot2c_f32_bf16 v5, s41, v79
    v_dot2c_f32_bf16 v6, v79, v79
    v_dot2c_f32_bf16 v7, s41, v80
    v_dot2c_f32_bf16 v8, v80, v80
    v_dot2c_f32_bf16 v5, s41, v81
    v_dot2c_f32_bf16 v6, v81, v81
    v_dot2c_f32_bf16 v7, s41, v82
    v_dot2c_f32_bf16 v8, v82, v82
    v_dot2c_f32_bf16 v5, s41, v83
    v_dot2c_f32_bf16 v6, v83, v83
    v_dot2c_f32_bf16 v7, s41, v84
    v_dot2c_f32_bf16 v8, v84, v84
    v_dot2c_f32_bf16 v5, s41, v85
    v_dot2c_f32_bf16 v6, v85, v85
    v_dot2c_f32_bf16 v7, s41, v86
    v_dot2c_f32_bf16 v8, v86, v86
    v_dot2c_f32_bf16 v5, s41, v87
    v_dot2c_f32_bf16 v6, v87, v87
    v_dot2c_f32_bf16 v7, s41, v88
    v_dot2c_f32_bf16 v8, v88, v88
    v_dot2c_f32_bf16 v5, s41, v89
    v_dot2c_f32_bf16 v6, v89, v89
    v_dot2c_f32_bf16 v7, s41, v90
    v_dot2c_f32_bf16 v8, v90, v90
    v_dot2c_f32_bf16 v5, s41, v91
    v_dot2c_f32_bf16 v6, v91, v91
    s_cbranch_scc0 sequential_preLN__softmax_full_mha__geglu_ffn__prompt_kernel_p1_sout
    s_barrier
    s_branch sequential_preLN__softmax_full_mha__geglu_ffn__prompt_kernel_p1_sloop
sequential_preLN__softmax_full_mha__geglu_ffn__prompt_kernel_p1_sout:
    s_barrier
    buffer_load_dwordx2 v[22:23], v10, s[12:15], 0 offen sc1
    v_add_f32 v5, v5, v7
    v_add_f32 v6, v6, v8
    s_nop 1
    v_permlane32_swap_b32 v5, v6
    v_add_f32 v5, v5, v6
    v_mov_b32 v6, v5
    s_nop 1
    v_permlane16_swap_b32 v5, v6
    v_add_f32 v5, v5, v6
    v_mov_b32 v6, v5
    s_nop 1
    v_permlane32_swap_b32 v5, v6
    s_barrier
    v_mul_f32 v5, 0x3b000000, v5
    v_mul_f32 v6, 0x3b000000, v6
    v_fma_f32 v6, -v5, v5, v6
    v_max_f32 v6, 0, v6
    v_cvt_pk_bf16_f32 v7, -v5, -v5
    v_cvt_pk_bf16_f32 v4, v6, v6
    v_lshlrev_b32 v4, 16, v4
    v_add_f32 v4, 0x3727c5ac, v4
    v_cvt_pk_bf16_f32 v4, v4, v4
    v_lshlrev_b32 v4, 16, v4
    v_sqrt_f32 v4, v4
    s_nop 0
    v_cvt_pk_bf16_f32 v4, v4, v4
    v_lshlrev_b32 v4, 16, v4
    v_rcp_f32 v8, v4
    s_nop 0
    ds_write2_b32 v1, v7, v8 offset0:0 offset1:64
    s_waitcnt lgkmcnt(0)
    s_barrier
    s_barrier
    s_barrier
    s_barrier
    s_barrier
    s_mov_b32 s63, 0x40000
sequential_preLN__softmax_full_mha__geglu_ffn__prompt_kernel_p1_tagw:
    s_waitcnt vmcnt(0)
    v_cmp_eq_u32 vcc, 0, v23
    s_sub_u32 s63, s63, 1
    s_cbranch_scc1 sequential_preLN__softmax_full_mha__geglu_ffn__prompt_kernel_p1_tagok
    s_cbranch_vccz sequential_preLN__softmax_full_mha__geglu_ffn__prompt_kernel_p1_tagok
    buffer_load_dwordx2 v[22:23], v10, s[12:15], 0 offen sc1
    s_branch sequential_preLN__softmax_full_mha__geglu_ffn__prompt_kernel_p1_tagw
sequential_preLN__softmax_full_mha__geglu_ffn__prompt_kernel_p1_tagok:
    ds_write_b64 v2, v[22:23]
    s_waitcnt lgkmcnt(0)
    s_setprio 0
    v_readfirstlane_b32 s84, v22
    v_readfirstlane_b32 s85, v23
    s_barrier
    s_barrier
    s_barrier
    s_barrier
    s_branch sequential_preLN__softmax_full_mha__geglu_ffn__prompt_kernel_p1_done
sequential_preLN__softmax_full_mha__geglu_ffn__prompt_kernel_p1_cons:
    s_branch sequential_preLN__softmax_full_mha__geglu_ffn__prompt_kernel_pad_e1
sequential_preLN__softmax_full_mha__geglu_ffn__prompt_kernel_ret_e1:
    v_lshlrev_b32 v3, 4, v0
    s_and_b32 s33, s24, 1
    s_bfe_u32 s34, s24, 0x10001
    v_bfe_u32 v1, v0, 1, 4
    v_mul_u32_u24 v4, 1040, v1
    v_lshl_add_u32 v4, v2, 4, v4
    v_and_b32 v1, 1, v0
    v_mul_u32_u24 v5, 640, v1
    v_mul_u32_u24 v7, 384, v1
    s_mul_i32 s38, s33, 16672
    s_mul_i32 s39, s33, 16608
    s_add_u32 s39, s39, 32
    v_add3_u32 v6, v5, v4, s39
    v_add3_u32 v8, v7, v4, s39
    v_add3_u32 v5, v5, v4, s38
    v_add3_u32 v7, v7, v4, s38
    v_lshlrev_b32 v12, 10, v2
    v_bfe_u32 v1, v0, 2, 2
    v_lshl_add_u32 v12, v1, 7, v12
    v_bfe_u32 v1, v0, 3, 1
    v_xor_b32 v1, s34, v1
    v_lshl_add_u32 v12, v1, 6, v12
    v_bfe_u32 v1, v0, 4, 1
    v_lshl_add_u32 v12, v1, 5, v12
    v_and_b32 v4, 3, v0
    v_lshl_add_u32 v12, v4, 3, v12
    s_lshl_b32 s28, s33, 11
    s_add_u32 s36, s28, 66560
    s_sub_u32 s37, 68608, s28
    v_add_u32 v9, s36, v12
    v_add_u32 v10, s37, v12
    v_add_u32 v11, 49152, v9
    v_add_u32 v12, 49152, v10
    v_bfe_u32 v4, v0, 2, 1
    v_cmp_eq_u32 vcc, v1, v4
    v_mov_b32 v4, 0x3f803f80
    v_lshlrev_b32 v14, 17, v1
    v_cndmask_b32 v24, 0, v4, vcc
    v_mov_b32 v25, v24
    v_mov_b32 v26, v24
    v_mov_b32 v27, v24
    v_mov_b32 v36, 0
    v_mov_b32 v37, 0
    v_mov_b32 v38, 0
    v_mov_b32 v39, 0
    v_mov_b32 v40, 0
    v_mov_b32 v41, 0
    v_mov_b32 v42, 0
    v_mov_b32 v43, 0
    v_lshl_add_u32 v14, v2, 8, v14
    v_and_b32 v4, 15, v0
    v_lshl_add_u32 v14, v4, 4, v14
    s_and_b32 s46, s24, 3
    s_lshl_b32 s27, s46, 8
    s_add_u32 s27, s27, 149504
    v_lshl_add_u32 v15, v0, 2, s27
    v_xor_b32 v19, 256, v15
    v_and_b32 v1, 31, v0
    s_lshl_b32 s27, s33, 7
    s_add_u32 s27, s27, 148480
    v_lshl_add_u32 v16, v1, 2, s27
    v_lshl_add_u32 v17, v2, 4, s27
    v_mov_b32 v22, 148992
    v_cmp_gt_u32 vcc, 32, v0
    s_lshl_b32 s27, s26, 2
    s_lshl_b32 s28, s34, 1
    s_add_u32 s27, s27, s28
    s_lshl_b32 s27, s27, 6
    s_lshl_b32 s28, s25, 1
    s_add_u32 s27, s27, s28
    s_add_u32 s27, s27, s33
    s_lshl_b32 s42, s27, 10
    s_add_u32 s43, s42, 0x10000
    s_lshl_b32 s44, s27, 11
    s_add_u32 s44, s44, 0x200000
    s_add_u32 s45, s44, 0x20000
    v_lshrrev_b32 v13, 1, v0
    v_lshlrev_b32 v13, 14, v13
    v_and_b32 v4, 1, v0
    v_lshl_add_u32 v13, v4, 12, v13
    s_lshl_b32 s27, s26, 9
    s_lshl_b32 s28, s34, 13
    s_add_u32 s27, s27, s28
    s_lshl_b32 s28, s25, 4
    s_add_u32 s27, s27, s28
    s_lshl_b32 s28, s33, 3
    s_add_u32 s27, s27, s28
    v_add_u32 v13, s27, v13
    s_waitcnt lgkmcnt(0)
    s_mov_b64 s[20:21], s[82:83]
    s_branch sequential_preLN__softmax_full_mha__geglu_ffn__prompt_kernel_pg_c1
.p2align 12
sequential_preLN__softmax_full_mha__geglu_ffn__prompt_kernel_pg_c1:
    s_barrier
    ds_read_b128 v[92:95], v5 offset:0
    ds_read_b64_tr_b16 v[100:101], v9 offset:0
    ds_read_b64_tr_b16 v[102:103], v9 offset:512
    ds_read_b128 v[96:99], v6 offset:0
    ds_read_b64_tr_b16 v[104:105], v10 offset:0
    ds_read_b64_tr_b16 v[106:107], v10 offset:512
    ds_read_b128 v[108:111], v5 offset:64
    ds_read_b64_tr_b16 v[116:117], v9 offset:4096
    ds_read_b64_tr_b16 v[118:119], v9 offset:4608
    ds_read_b128 v[112:115], v6 offset:64
    ds_read_b64_tr_b16 v[120:121], v10 offset:4096
    ds_read_b64_tr_b16 v[122:123], v10 offset:4608
    s_waitcnt lgkmcnt(6)
    v_mfma_f32_32x32x16_bf16 v[60:75], v[100:103], v[92:95], 0
    ds_read_b128 v[124:127], v7 offset:128
    ds_read_b64_tr_b16 v[132:133], v9 offset:8192
    ds_read_b64_tr_b16 v[134:135], v9 offset:8704
    v_mfma_f32_32x32x16_bf16 v[60:75], v[104:107], v[96:99], v[60:75]
    ds_read_b128 v[128:131], v8 offset:128
    ds_read_b64_tr_b16 v[136:137], v10 offset:8192
    ds_read_b64_tr_b16 v[138:139], v10 offset:8704
    v_mfma_f32_16x16x32_bf16 v[28:31], v[24:27], v[100:103], 0
    s_waitcnt lgkmcnt(6)
    v_mfma_f32_32x32x16_bf16 v[60:75], v[116:119], v[108:111], v[60:75]
    ds_read_b128 v[92:95], v7 offset:192
    ds_read_b64_tr_b16 v[100:101], v9 offset:12288
    ds_read_b64_tr_b16 v[102:103], v9 offset:12800
    v_mfma_f32_32x32x16_bf16 v[60:75], v[120:123], v[112:115], v[60:75]
    ds_read_b128 v[96:99], v8 offset:192
    ds_read_b64_tr_b16 v[104:105], v10 offset:12288
    ds_read_b64_tr_b16 v[106:107], v10 offset:12800
    v_mfma_f32_16x16x32_bf16 v[28:31], v[24:27], v[116:119], v[28:31]
    s_barrier
    s_waitcnt lgkmcnt(6)
    v_mfma_f32_32x32x16_bf16 v[60:75], v[132:135], v[124:127], v[60:75]
    ds_read_b128 v[108:111], v5 offset:256
    ds_read_b64_tr_b16 v[116:117], v9 offset:16384
    ds_read_b64_tr_b16 v[118:119], v9 offset:16896
    v_mfma_f32_32x32x16_bf16 v[60:75], v[136:139], v[128:131], v[60:75]
    ds_read_b128 v[112:115], v6 offset:256
    ds_read_b64_tr_b16 v[120:121], v10 offset:16384
    ds_read_b64_tr_b16 v[122:123], v10 offset:16896
    v_mfma_f32_16x16x32_bf16 v[28:31], v[24:27], v[132:135], v[28:31]
    s_waitcnt lgkmcnt(6)
    v_mfma_f32_32x32x16_bf16 v[60:75], v[100:103], v[92:95], v[60:75]
    ds_read_b128 v[124:127], v5 offset:320
    ds_read_b64_tr_b16 v[132:133], v9 offset:20480
    ds_read_b64_tr_b16 v[134:135], v9 offset:20992
    v_mfma_f32_32x32x16_bf16 v[60:75], v[104:107], v[96:99], v[60:75]
    ds_read_b128 v[128:131], v6 offset:320
    ds_read_b64_tr_b16 v[136:137], v10 offset:20480
    ds_read_b64_tr_b16 v[138:139], v10 offset:20992
    v_mfma_f32_16x16x32_bf16 v[28:31], v[24:27], v[100:103], v[28:31]
    s_waitcnt lgkmcnt(6)
    v_mfma_f32_32x32x16_bf16 v[60:75], v[116:119], v[108:111], v[60:75]
    ds_read_b128 v[92:95], v7 offset:384
    ds_read_b64_tr_b16 v[100:101], v9 offset:24576
    ds_read_b64_tr_b16 v[102:103], v9 offset:25088
    v_mfma_f32_32x32x16_bf16 v[60:75], v[120:123], v[112:115], v[60:75]
    ds_read_b128 v[96:99], v8 offset:384
    ds_read_b64_tr_b16 v[104:105], v10 offset:24576
    ds_read_b64_tr_b16 v[106:107], v10 offset:25088
    v_mfma_f32_16x16x32_bf16 v[28:31], v[24:27], v[116:119], v[28:31]
    s_waitcnt lgkmcnt(6)
    v_mfma_f32_32x32x16_bf16 v[60:75], v[132:135], v[124:127], v[60:75]
    ds_read_b128 v[108:111], v7 offset:448
    ds_read_b64_tr_b16 v[116:117], v9 offset:28672
    ds_read_b64_tr_b16 v[118:119], v9 offset:29184
    v_mfma_f32_32x32x16_bf16 v[60:75], v[136:139], v[128:131], v[60:75]
    ds_read_b128 v[112:115], v8 offset:448
    ds_read_b64_tr_b16 v[120:121], v10 offset:28672
    ds_read_b64_tr_b16 v[122:123], v10 offset:29184
    v_mfma_f32_16x16x32_bf16 v[28:31], v[24:27], v[132:135], v[28:31]
    s_barrier
    s_waitcnt lgkmcnt(6)
    v_mfma_f32_32x32x16_bf16 v[60:75], v[100:103], v[92:95], v[60:75]
    ds_read_b128 v[124:127], v5 offset:33280
    ds_read_b64_tr_b16 v[132:133], v9 offset:32768
    ds_read_b64_tr_b16 v[134:135], v9 offset:33280
    v_mfma_f32_32x32x16_bf16 v[60:75], v[104:107], v[96:99], v[60:75]
    ds_read_b128 v[128:131], v6 offset:33280
    ds_read_b64_tr_b16 v[136:137], v10 offset:32768
    ds_read_b64_tr_b16 v[138:139], v10 offset:33280
    v_mfma_f32_16x16x32_bf16 v[28:31], v[24:27], v[100:103], v[28:31]
    s_waitcnt lgkmcnt(6)
    v_mfma_f32_32x32x16_bf16 v[60:75], v[116:119], v[108:111], v[60:75]
    ds_read_b128 v[92:95], v5 offset:33344
    ds_read_b64_tr_b16 v[100:101], v9 offset:36864
    ds_read_b64_tr_b16 v[102:103], v9 offset:37376
    v_mfma_f32_32x32x16_bf16 v[60:75], v[120:123], v[112:115], v[60:75]
    ds_read_b128 v[96:99], v6 offset:33344
    ds_read_b64_tr_b16 v[104:105], v10 offset:36864
    ds_read_b64_tr_b16 v[106:107], v10 offset:37376
    v_mfma_f32_16x16x32_bf16 v[28:31], v[24:27], v[116:119], v[28:31]
    s_waitcnt lgkmcnt(6)
    v_mfma_f32_32x32x16_bf16 v[60:75], v[132:135], v[124:127], v[60:75]
    ds_read_b128 v[108:111], v7 offset:33408
    ds_read_b64_tr_b16 v[116:117], v9 offset:40960
    ds_read_b64_tr_b16 v[118:119], v9 offset:41472
    v_mfma_f32_32x32x16_bf16 v[60:75], v[136:139], v[128:131], v[60:75]
    ds_read_b128 v[112:115], v8 offset:33408
    ds_read_b64_tr_b16 v[120:121], v10 offset:40960
    ds_read_b64_tr_b16 v[122:123], v10 offset:41472
    v_mfma_f32_16x16x32_bf16 v[28:31], v[24:27], v[132:135], v[28:31]
    s_waitcnt lgkmcnt(6)
    v_mfma_f32_32x32x16_bf16 v[60:75], v[100:103], v[92:95], v[60:75]
    ds_read_b128 v[124:127], v7 offset:33472
    ds_read_b64_tr_b16 v[132:133], v9 offset:45056
    ds_read_b64_tr_b16 v[134:135], v9 offset:45568
    v_mfma_f32_32x32x16_bf16 v[60:75], v[104:107], v[96:99], v[60:75]
    ds_read_b128 v[128:131], v8 offset:33472
    ds_read_b64_tr_b16 v[136:137], v10 offset:45056
    ds_read_b64_tr_b16 v[138:139], v10 offset:45568
    v_mfma_f32_16x16x32_bf16 v[28:31], v[24:27], v[100:103], v[28:31]
    s_barrier
    s_waitcnt lgkmcnt(6)
    v_mfma_f32_32x32x16_bf16 v[60:75], v[116:119], v[108:111], v[60:75]
    ds_read_b128 v[92:95], v5 offset:33536
    ds_read_b64_tr_b16 v[100:101], v11 offset:0
    ds_read_b64_tr_b16 v[102:103], v11 offset:512
    v_mfma_f32_32x32x16_bf16 v[60:75], v[120:123], v[112:115], v[60:75]
    ds_read_b128 v[96:99], v6 offset:33536
    ds_read_b64_tr_b16 v[104:105], v12 offset:0
    ds_read_b64_tr_b16 v[106:107], v12 offset:512
    v_mfma_f32_16x16x32_bf16 v[28:31], v[24:27], v[116:119], v[28:31]
    s_waitcnt lgkmcnt(6)
    v_mfma_f32_32x32x16_bf16 v[60:75], v[132:135], v[124:127], v[60:75]
    ds_read_b128 v[108:111], v5 offset:33600
    ds_read_b64_tr_b16 v[116:117], v11 offset:4096
    ds_read_b64_tr_b16 v[118:119], v11 offset:4608
    v_mfma_f32_32x32x16_bf16 v[60:75], v[136:139], v[128:131], v[60:75]
    ds_read_b128 v[112:115], v6 offset:33600
    ds_read_b64_tr_b16 v[120:121], v12 offset:4096
    ds_read_b64_tr_b16 v[122:123], v12 offset:4608
    v_mfma_f32_16x16x32_bf16 v[28:31], v[24:27], v[132:135], v[28:31]
    s_waitcnt lgkmcnt(6)
    v_mfma_f32_32x32x16_bf16 v[60:75], v[100:103], v[92:95], v[60:75]
    ds_read_b128 v[124:127], v7 offset:33664
    ds_read_b64_tr_b16 v[132:133], v11 offset:8192
    ds_read_b64_tr_b16 v[134:135], v11 offset:8704
    v_mfma_f32_32x32x16_bf16 v[60:75], v[104:107], v[96:99], v[60:75]
    ds_read_b128 v[128:131], v8 offset:33664
    ds_read_b64_tr_b16 v[136:137], v12 offset:8192
    ds_read_b64_tr_b16 v[138:139], v12 offset:8704
    v_mfma_f32_16x16x32_bf16 v[28:31], v[24:27], v[100:103], v[28:31]
    s_waitcnt lgkmcnt(6)
    v_mfma_f32_32x32x16_bf16 v[60:75], v[116:119], v[108:111], v[60:75]
    ds_read_b128 v[92:95], v7 offset:33728
    ds_read_b64_tr_b16 v[100:101], v11 offset:12288
    ds_read_b64_tr_b16 v[102:103], v11 offset:12800
    v_mfma_f32_32x32x16_bf16 v[60:75], v[120:123], v[112:115], v[60:75]
    ds_read_b128 v[96:99], v8 offset:33728
    ds_read_b64_tr_b16 v[104:105], v12 offset:12288
    ds_read_b64_tr_b16 v[106:107], v12 offset:12800
    v_mfma_f32_16x16x32_bf16 v[28:31], v[24:27], v[116:119], v[28:31]
    s_barrier
    s_waitcnt lgkmcnt(6)
    v_mfma_f32_32x32x16_bf16 v[60:75], v[132:135], v[124:127], v[60:75]
    ds_read_b128 v[108:111], v5 offset:0
    ds_read_b64_tr_b16 v[116:117], v11 offset:16384
    ds_read_b64_tr_b16 v[118:119], v11 offset:16896
    v_mfma_f32_32x32x16_bf16 v[60:75], v[136:139], v[128:131], v[60:75]
    ds_read_b128 v[112:115], v6 offset:0
    ds_read_b64_tr_b16 v[120:121], v12 offset:16384
    ds_read_b64_tr_b16 v[122:123], v12 offset:16896
    v_mfma_f32_16x16x32_bf16 v[28:31], v[24:27], v[132:135], v[28:31]
    s_waitcnt lgkmcnt(6)
    v_mfma_f32_32x32x16_bf16 v[60:75], v[100:103], v[92:95], v[60:75]
    ds_read_b128 v[124:127], v5 offset:64
    ds_read_b64_tr_b16 v[132:133], v11 offset:20480
    ds_read_b64_tr_b16 v[134:135], v11 offset:20992
    v_mfma_f32_32x32x16_bf16 v[60:75], v[104:107], v[96:99], v[60:75]
    ds_read_b128 v[128:131], v6 offset:64
    ds_read_b64_tr_b16 v[136:137], v12 offset:20480
    ds_read_b64_tr_b16 v[138:139], v12 offset:20992
    v_mfma_f32_16x16x32_bf16 v[28:31], v[24:27], v[100:103], v[28:31]
    s_waitcnt lgkmcnt(6)
    v_mfma_f32_32x32x16_bf16 v[76:91], v[108:111], v[116:119], 0
    ds_read_b128 v[92:95], v7 offset:128
    ds_read_b64_tr_b16 v[100:101], v11 offset:24576
    ds_read_b64_tr_b16 v[102:103], v11 offset:25088
    v_mfma_f32_32x32x16_bf16 v[76:91], v[112:115], v[120:123], v[76:91]
    ds_read_b128 v[96:99], v8 offset:128
    ds_read_b64_tr_b16 v[104:105], v12 offset:24576
    ds_read_b64_tr_b16 v[106:107], v12 offset:25088
    v_mfma_f32_16x16x32_bf16 v[32:35], v[24:27], v[116:119], 0
    s_waitcnt lgkmcnt(6)
    v_mfma_f32_32x32x16_bf16 v[76:91], v[124:127], v[132:135], v[76:91]
    ds_read_b128 v[108:111], v7 offset:192
    ds_read_b64_tr_b16 v[116:117], v11 offset:28672
    ds_read_b64_tr_b16 v[118:119], v11 offset:29184
    ds_write_b32 v15, v28 offset:0
    v_mfma_f32_32x32x16_bf16 v[76:91], v[128:131], v[136:139], v[76:91]
    ds_read_b128 v[112:115], v8 offset:192
    ds_read_b64_tr_b16 v[120:121], v12 offset:28672
    ds_read_b64_tr_b16 v[122:123], v12 offset:29184
    v_mfma_f32_16x16x32_bf16 v[32:35], v[24:27], v[132:135], v[32:35]
    s_waitcnt lgkmcnt(3)
    s_barrier
    v_mfma_f32_32x32x16_bf16 v[76:91], v[92:95], v[100:103], v[76:91]
    ds_read_b128 v[124:127], v5 offset:256
    ds_read_b64_tr_b16 v[132:133], v9 offset:0
    ds_read_b64_tr_b16 v[134:135], v9 offset:512
    ds_read_b32 v18, v19 offset:0
    v_mfma_f32_32x32x16_bf16 v[76:91], v[96:99], v[104:107], v[76:91]
    ds_read_b128 v[128:131], v6 offset:256
    ds_read_b64_tr_b16 v[136:137], v10 offset:0
    ds_read_b64_tr_b16 v[138:139], v10 offset:512
    v_mfma_f32_16x16x32_bf16 v[32:35], v[24:27], v[100:103], v[32:35]
    s_waitcnt lgkmcnt(7)
    v_mfma_f32_32x32x16_bf16 v[76:91], v[108:111], v[116:119], v[76:91]
    ds_read_b128 v[92:95], v5 offset:320
    ds_read_b64_tr_b16 v[100:101], v9 offset:4096
    ds_read_b64_tr_b16 v[102:103], v9 offset:4608
    ds_read_b32 v36, v16
    v_mfma_f32_32x32x16_bf16 v[76:91], v[112:115], v[120:123], v[76:91]
    ds_read_b128 v[96:99], v6 offset:320
    ds_read_b64_tr_b16 v[104:105], v10 offset:4096
    ds_read_b64_tr_b16 v[106:107], v10 offset:4608
    v_mfma_f32_16x16x32_bf16 v[32:35], v[24:27], v[116:119], v[32:35]
    s_waitcnt lgkmcnt(7)
    v_mfma_f32_32x32x16_bf16 v[76:91], v[124:127], v[132:135], v[76:91]
    ds_read_b128 v[108:111], v7 offset:384
    ds_read_b64_tr_b16 v[116:117], v9 offset:8192
    ds_read_b64_tr_b16 v[118:119], v9 offset:8704
    ds_read_b32 v20, v16 offset:256
    v_mfma_f32_32x32x16_bf16 v[76:91], v[128:131], v[136:139], v[76:91]
    ds_read_b128 v[112:115], v8 offset:384
    ds_read_b64_tr_b16 v[120:121], v10 offset:8192
    ds_read_b64_tr_b16 v[122:123], v10 offset:8704
    v_mfma_f32_16x16x32_bf16 v[32:35], v[24:27], v[132:135], v[32:35]
    s_waitcnt lgkmcnt(7)
    v_mfma_f32_32x32x16_bf16 v[76:91], v[92:95], v[100:103], v[76:91]
    ds_read_b128 v[124:127], v7 offset:448
    ds_read_b64_tr_b16 v[132:133], v9 offset:12288
    ds_read_b64_tr_b16 v[134:135], v9 offset:12800
    s_waitcnt lgkmcnt(6)
    v_add_f32 v18, v18, v28
    v_cndmask_b32 v36, 0, v36, vcc
    v_mfma_f32_32x32x16_bf16 v[76:91], v[96:99], v[104:107], v[76:91]
    ds_read_b128 v[128:131], v8 offset:448
    ds_read_b64_tr_b16 v[136:137], v10 offset:12288
    ds_read_b64_tr_b16 v[138:139], v10 offset:12800
    v_mul_f32 v21, 0x3eb8aa3b, v20
    v_cvt_pk_bf16_f32 v4, v18, v18
    v_lshlrev_b32 v4, 16, v4
    v_mfma_f32_16x16x32_bf16 v[32:35], v[24:27], v[100:103], v[32:35]
    s_barrier
    s_waitcnt lgkmcnt(6)
    v_mfma_f32_32x32x16_bf16 v[76:91], v[108:111], v[116:119], v[76:91]
    ds_read_b128 v[92:95], v5 offset:33280
    ds_read_b64_tr_b16 v[100:101], v9 offset:16384
    ds_read_b64_tr_b16 v[102:103], v9 offset:16896
    v_sub_f32 v4, v18, v4
    v_cvt_pk_bf16_f32 v40, v18, v4
    v_mfma_f32_32x32x16_bf16 v[76:91], v[112:115], v[120:123], v[76:91]
    ds_read_b128 v[96:99], v6 offset:33280
    ds_read_b64_tr_b16 v[104:105], v10 offset:16384
    ds_read_b64_tr_b16 v[106:107], v10 offset:16896
    s_nop 1
    v_mfma_f32_32x32x16_bf16 v[60:75], v[40:43], v[36:39], v[60:75]
    v_mfma_f32_16x16x32_bf16 v[32:35], v[24:27], v[116:119], v[32:35]
    s_waitcnt lgkmcnt(6)
    v_mfma_f32_32x32x16_bf16 v[76:91], v[124:127], v[132:135], v[76:91]
    ds_read_b128 v[108:111], v5 offset:33344
    ds_read_b64_tr_b16 v[116:117], v9 offset:20480
    ds_read_b64_tr_b16 v[118:119], v9 offset:20992
    v_mfma_f32_32x32x16_bf16 v[76:91], v[128:131], v[136:139], v[76:91]
    ds_read_b128 v[112:115], v6 offset:33344
    ds_read_b64_tr_b16 v[120:121], v10 offset:20480
    ds_read_b64_tr_b16 v[122:123], v10 offset:20992
    v_mfma_f32_16x16x32_bf16 v[32:35], v[24:27], v[132:135], v[32:35]
    s_waitcnt lgkmcnt(6)
    v_mfma_f32_32x32x16_bf16 v[76:91], v[92:95], v[100:103], v[76:91]
    ds_read_b128 v[124:127], v7 offset:33408
    ds_read_b64_tr_b16 v[132:133], v9 offset:24576
    ds_read_b64_tr_b16 v[134:135], v9 offset:25088
    v_mul_f32 v60, v20, v60
    v_mul_f32 v61, v20, v61
    v_mul_f32 v62, v20, v62
    v_mfma_f32_32x32x16_bf16 v[76:91], v[96:99], v[104:107], v[76:91]
    ds_read_b128 v[128:131], v8 offset:33408
    ds_read_b64_tr_b16 v[136:137], v10 offset:24576
    ds_read_b64_tr_b16 v[138:139], v10 offset:25088
    v_mul_f32 v63, v20, v63
    v_mul_f32 v64, v20, v64
    v_mfma_f32_16x16x32_bf16 v[32:35], v[24:27], v[100:103], v[32:35]
    s_waitcnt lgkmcnt(6)
    v_mfma_f32_32x32x16_bf16 v[76:91], v[108:111], v[116:119], v[76:91]
    ds_read_b128 v[92:95], v7 offset:33472
    ds_read_b64_tr_b16 v[100:101], v9 offset:28672
    ds_read_b64_tr_b16 v[102:103], v9 offset:29184
    v_mul_f32 v65, v20, v65
    v_mul_f32 v66, v20, v66
    v_mul_f32 v67, v20, v67
    v_mfma_f32_32x32x16_bf16 v[76:91], v[112:115], v[120:123], v[76:91]
    ds_read_b128 v[96:99], v8 offset:33472
    ds_read_b64_tr_b16 v[104:105], v10 offset:28672
    ds_read_b64_tr_b16 v[106:107], v10 offset:29184
    v_cvt_pk_bf16_f32 v60, v60, v61
    v_cvt_pk_bf16_f32 v61, v62, v63
    v_mfma_f32_16x16x32_bf16 v[32:35], v[24:27], v[116:119], v[32:35]
    s_barrier
    s_waitcnt lgkmcnt(6)
    v_mfma_f32_32x32x16_bf16 v[76:91], v[124:127], v[132:135], v[76:91]
    ds_read_b128 v[108:111], v5 offset:33536
    ds_read_b64_tr_b16 v[116:117], v9 offset:32768
    ds_read_b64_tr_b16 v[118:119], v9 offset:33280
    v_cvt_pk_bf16_f32 v62, v64, v65
    v_cvt_pk_bf16_f32 v63, v66, v67
    buffer_store_dwordx4 v[60:63], v3, s[20:23], s44 offen sc1
    v_mfma_f32_32x32x16_bf16 v[76:91], v[128:131], v[136:139], v[76:91]
    ds_read_b128 v[112:115], v6 offset:33536
    ds_read_b64_tr_b16 v[120:121], v10 offset:32768
    ds_read_b64_tr_b16 v[122:123], v10 offset:33280
    v_mul_f32 v68, v20, v68
    v_mul_f32 v69, v20, v69
    v_mfma_f32_16x16x32_bf16 v[32:35], v[24:27], v[132:135], v[32:35]
    s_waitcnt lgkmcnt(6)
    v_mfma_f32_32x32x16_bf16 v[76:91], v[92:95], v[100:103], v[76:91]
    ds_read_b128 v[124:127], v5 offset:33600
    ds_read_b64_tr_b16 v[132:133], v9 offset:36864
    ds_read_b64_tr_b16 v[134:135], v9 offset:37376
    v_mul_f32 v70, v20, v70
    v_mul_f32 v71, v20, v71
    v_mul_f32 v72, v20, v72
    v_mfma_f32_32x32x16_bf16 v[76:91], v[96:99], v[104:107], v[76:91]
    ds_read_b128 v[128:131], v6 offset:33600
    ds_read_b64_tr_b16 v[136:137], v10 offset:36864
    ds_read_b64_tr_b16 v[138:139], v10 offset:37376
    v_mul_f32 v73, v20, v73
    v_mul_f32 v74, v20, v74
    v_mfma_f32_16x16x32_bf16 v[32:35], v[24:27], v[100:103], v[32:35]
    s_branch sequential_preLN__softmax_full_mha__geglu_ffn__prompt_kernel_pg_e1
.p2align 12
sequential_preLN__softmax_full_mha__geglu_ffn__prompt_kernel_pad_e1:
    s_branch sequential_preLN__softmax_full_mha__geglu_ffn__prompt_kernel_ret_e1
sequential_preLN__softmax_full_mha__geglu_ffn__prompt_kernel_pg_e1:
    s_waitcnt lgkmcnt(6)
    v_mfma_f32_32x32x16_bf16 v[76:91], v[108:111], v[116:119], v[76:91]
    ds_read_b128 v[92:95], v7 offset:33664
    ds_read_b64_tr_b16 v[100:101], v9 offset:40960
    ds_read_b64_tr_b16 v[102:103], v9 offset:41472
    v_mul_f32 v75, v20, v75
    v_cvt_pk_bf16_f32 v64, v68, v69
    v_cvt_pk_bf16_f32 v65, v70, v71
    v_mfma_f32_32x32x16_bf16 v[76:91], v[112:115], v[120:123], v[76:91]
    ds_read_b128 v[96:99], v8 offset:33664
    ds_read_b64_tr_b16 v[104:105], v10 offset:40960
    ds_read_b64_tr_b16 v[106:107], v10 offset:41472
    v_cvt_pk_bf16_f32 v66, v72, v73
    v_cvt_pk_bf16_f32 v67, v74, v75
    ds_read_b128 v[44:47], v17 offset:256
    v_mfma_f32_16x16x32_bf16 v[32:35], v[24:27], v[116:119], v[32:35]
    s_waitcnt lgkmcnt(7)
    v_mfma_f32_32x32x16_bf16 v[76:91], v[124:127], v[132:135], v[76:91]
    ds_read_b128 v[108:111], v7 offset:33728
    ds_read_b64_tr_b16 v[116:117], v9 offset:45056
    ds_read_b64_tr_b16 v[118:119], v9 offset:45568
    buffer_store_dwordx4 v[64:67], v3, s[20:23], s45 offen sc1
    v_mfma_f32_32x32x16_bf16 v[76:91], v[128:131], v[136:139], v[76:91]
    ds_read_b128 v[112:115], v8 offset:33728
    ds_read_b64_tr_b16 v[120:121], v10 offset:45056
    ds_read_b64_tr_b16 v[122:123], v10 offset:45568
    ds_read_b128 v[48:51], v17 offset:288
    v_mfma_f32_16x16x32_bf16 v[32:35], v[24:27], v[132:135], v[32:35]
    s_barrier
    s_waitcnt lgkmcnt(8)
    v_mfma_f32_32x32x16_bf16 v[76:91], v[92:95], v[100:103], v[76:91]
    ds_read_b128 v[124:127], v5 offset:0
    ds_read_b64_tr_b16 v[132:133], v11 offset:0
    ds_read_b64_tr_b16 v[134:135], v11 offset:512
    ds_read_b128 v[52:55], v17 offset:320
    v_mfma_f32_32x32x16_bf16 v[76:91], v[96:99], v[104:107], v[76:91]
    ds_read_b128 v[128:131], v6 offset:0
    ds_read_b64_tr_b16 v[136:137], v12 offset:0
    ds_read_b64_tr_b16 v[138:139], v12 offset:512
    v_mfma_f32_16x16x32_bf16 v[32:35], v[24:27], v[100:103], v[32:35]
    s_waitcnt lgkmcnt(8)
    v_mfma_f32_32x32x16_bf16 v[76:91], v[108:111], v[116:119], v[76:91]
    ds_read_b128 v[92:95], v5 offset:64
    ds_read_b64_tr_b16 v[100:101], v11 offset:4096
    ds_read_b64_tr_b16 v[102:103], v11 offset:4608
    ds_read_b128 v[56:59], v17 offset:352
    v_mfma_f32_32x32x16_bf16 v[76:91], v[112:115], v[120:123], v[76:91]
    ds_read_b128 v[96:99], v6 offset:64
    ds_read_b64_tr_b16 v[104:105], v12 offset:4096
    ds_read_b64_tr_b16 v[106:107], v12 offset:4608
    v_mfma_f32_16x16x32_bf16 v[32:35], v[24:27], v[116:119], v[32:35]
    s_waitcnt lgkmcnt(7)
    v_mfma_f32_32x32x16_bf16 v[60:75], v[132:135], v[124:127], 0
    ds_read_b128 v[108:111], v7 offset:128
    ds_read_b64_tr_b16 v[116:117], v11 offset:8192
    ds_read_b64_tr_b16 v[118:119], v11 offset:8704
    v_mfma_f32_32x32x16_bf16 v[60:75], v[136:139], v[128:131], v[60:75]
    ds_read_b128 v[112:115], v8 offset:128
    ds_read_b64_tr_b16 v[120:121], v12 offset:8192
    ds_read_b64_tr_b16 v[122:123], v12 offset:8704
    v_mfma_f32_16x16x32_bf16 v[28:31], v[24:27], v[132:135], 0
    s_waitcnt lgkmcnt(6)
    v_mfma_f32_32x32x16_bf16 v[60:75], v[100:103], v[92:95], v[60:75]
    ds_read_b128 v[124:127], v7 offset:192
    ds_read_b64_tr_b16 v[132:133], v11 offset:12288
    ds_read_b64_tr_b16 v[134:135], v11 offset:12800
    ds_write_b32 v15, v32 offset:1024
    v_mfma_f32_32x32x16_bf16 v[60:75], v[104:107], v[96:99], v[60:75]
    ds_read_b128 v[128:131], v8 offset:192
    ds_read_b64_tr_b16 v[136:137], v12 offset:12288
    ds_read_b64_tr_b16 v[138:139], v12 offset:12800
    v_mfma_f32_16x16x32_bf16 v[28:31], v[24:27], v[100:103], v[28:31]
    s_waitcnt lgkmcnt(3)
    s_barrier
    v_mfma_f32_32x32x16_bf16 v[60:75], v[116:119], v[108:111], v[60:75]
    ds_read_b128 v[92:95], v5 offset:256
    ds_read_b64_tr_b16 v[100:101], v11 offset:16384
    ds_read_b64_tr_b16 v[102:103], v11 offset:16896
    ds_read_b32 v18, v19 offset:1024
    v_mfma_f32_32x32x16_bf16 v[60:75], v[120:123], v[112:115], v[60:75]
    ds_read_b128 v[96:99], v6 offset:256
    ds_read_b64_tr_b16 v[104:105], v12 offset:16384
    ds_read_b64_tr_b16 v[106:107], v12 offset:16896
    v_mfma_f32_16x16x32_bf16 v[28:31], v[24:27], v[116:119], v[28:31]
    s_waitcnt lgkmcnt(7)
    v_mfma_f32_32x32x16_bf16 v[60:75], v[132:135], v[124:127], v[60:75]
    ds_read_b128 v[108:111], v5 offset:320
    ds_read_b64_tr_b16 v[116:117], v11 offset:20480
    ds_read_b64_tr_b16 v[118:119], v11 offset:20992
    s_waitcnt lgkmcnt(6)
    v_add_f32 v18, v18, v32
    v_cvt_pk_bf16_f32 v4, v18, v18
    v_mfma_f32_32x32x16_bf16 v[60:75], v[136:139], v[128:131], v[60:75]
    ds_read_b128 v[112:115], v6 offset:320
    ds_read_b64_tr_b16 v[120:121], v12 offset:20480
    ds_read_b64_tr_b16 v[122:123], v12 offset:20992
    v_lshlrev_b32 v4, 16, v4
    v_sub_f32 v4, v18, v4
    v_cvt_pk_bf16_f32 v40, v18, v4
    v_mfma_f32_16x16x32_bf16 v[28:31], v[24:27], v[132:135], v[28:31]
    s_waitcnt lgkmcnt(6)
    v_mfma_f32_32x32x16_bf16 v[60:75], v[100:103], v[92:95], v[60:75]
    ds_read_b128 v[124:127], v7 offset:384
    ds_read_b64_tr_b16 v[132:133], v11 offset:24576
    ds_read_b64_tr_b16 v[134:135], v11 offset:25088
    s_nop 1
    v_mfma_f32_32x32x16_bf16 v[76:91], v[36:39], v[40:43], v[76:91]
    v_mfma_f32_32x32x16_bf16 v[60:75], v[104:107], v[96:99], v[60:75]
    ds_read_b128 v[128:131], v8 offset:384
    ds_read_b64_tr_b16 v[136:137], v12 offset:24576
    ds_read_b64_tr_b16 v[138:139], v12 offset:25088
    v_mfma_f32_16x16x32_bf16 v[28:31], v[24:27], v[100:103], v[28:31]
    s_waitcnt lgkmcnt(6)
    v_mfma_f32_32x32x16_bf16 v[60:75], v[116:119], v[108:111], v[60:75]
    ds_read_b128 v[92:95], v7 offset:448
    ds_read_b64_tr_b16 v[100:101], v11 offset:28672
    ds_read_b64_tr_b16 v[102:103], v11 offset:29184
    v_mfma_f32_32x32x16_bf16 v[60:75], v[120:123], v[112:115], v[60:75]
    ds_read_b128 v[96:99], v8 offset:448
    ds_read_b64_tr_b16 v[104:105], v12 offset:28672
    ds_read_b64_tr_b16 v[106:107], v12 offset:29184
    v_mfma_f32_16x16x32_bf16 v[28:31], v[24:27], v[116:119], v[28:31]
    s_barrier
    s_waitcnt lgkmcnt(6)
    v_mfma_f32_32x32x16_bf16 v[60:75], v[132:135], v[124:127], v[60:75]
    ds_read_b128 v[108:111], v5 offset:33280
    ds_read_b64_tr_b16 v[116:117], v9 offset:0
    ds_read_b64_tr_b16 v[118:119], v9 offset:512
    v_mul_f32 v76, v44, v76
    v_mul_f32 v77, v45, v77
    v_mul_f32 v78, v46, v78
    v_mfma_f32_32x32x16_bf16 v[60:75], v[136:139], v[128:131], v[60:75]
    ds_read_b128 v[112:115], v6 offset:33280
    ds_read_b64_tr_b16 v[120:121], v10 offset:0
    ds_read_b64_tr_b16 v[122:123], v10 offset:512
    v_mul_f32 v79, v47, v79
    v_mul_f32 v80, v48, v80
    v_mfma_f32_16x16x32_bf16 v[28:31], v[24:27], v[132:135], v[28:31]
    s_waitcnt lgkmcnt(6)
    v_mfma_f32_32x32x16_bf16 v[60:75], v[100:103], v[92:95], v[60:75]
    ds_read_b128 v[124:127], v5 offset:33344
    ds_read_b64_tr_b16 v[132:133], v9 offset:4096
    ds_read_b64_tr_b16 v[134:135], v9 offset:4608
    v_mul_f32 v81, v49, v81
    v_mul_f32 v82, v50, v82
    v_mul_f32 v83, v51, v83
    v_mfma_f32_32x32x16_bf16 v[60:75], v[104:107], v[96:99], v[60:75]
    ds_read_b128 v[128:131], v6 offset:33344
    ds_read_b64_tr_b16 v[136:137], v10 offset:4096
    ds_read_b64_tr_b16 v[138:139], v10 offset:4608
    v_cvt_pk_bf16_f32 v76, v76, v77
    v_cvt_pk_bf16_f32 v77, v78, v79
    v_mfma_f32_16x16x32_bf16 v[28:31], v[24:27], v[100:103], v[28:31]
    s_waitcnt lgkmcnt(6)
    v_mfma_f32_32x32x16_bf16 v[60:75], v[116:119], v[108:111], v[60:75]
    ds_read_b128 v[92:95], v7 offset:33408
    ds_read_b64_tr_b16 v[100:101], v9 offset:8192
    ds_read_b64_tr_b16 v[102:103], v9 offset:8704
    v_cvt_pk_bf16_f32 v78, v80, v81
    v_cvt_pk_bf16_f32 v79, v82, v83
    v_mul_f32 v84, v52, v84
    v_mfma_f32_32x32x16_bf16 v[60:75], v[120:123], v[112:115], v[60:75]
    ds_read_b128 v[96:99], v8 offset:33408
    ds_read_b64_tr_b16 v[104:105], v10 offset:8192
    ds_read_b64_tr_b16 v[106:107], v10 offset:8704
    v_mul_f32 v85, v53, v85
    v_mul_f32 v86, v54, v86
    v_mfma_f32_16x16x32_bf16 v[28:31], v[24:27], v[116:119], v[28:31]
    s_waitcnt lgkmcnt(6)
    v_mfma_f32_32x32x16_bf16 v[60:75], v[132:135], v[124:127], v[60:75]
    ds_read_b128 v[108:111], v7 offset:33472
    ds_read_b64_tr_b16 v[116:117], v9 offset:12288
    ds_read_b64_tr_b16 v[118:119], v9 offset:12800
    v_mul_f32 v87, v55, v87
    v_mul_f32 v88, v56, v88
    v_mul_f32 v89, v57, v89
    v_mfma_f32_32x32x16_bf16 v[60:75], v[136:139], v[128:131], v[60:75]
    ds_read_b128 v[112:115], v8 offset:33472
    ds_read_b64_tr_b16 v[120:121], v10 offset:12288
    ds_read_b64_tr_b16 v[122:123], v10 offset:12800
    v_mul_f32 v90, v58, v90
    v_mul_f32 v91, v59, v91
    v_mfma_f32_16x16x32_bf16 v[28:31], v[24:27], v[132:135], v[28:31]
    s_barrier
    s_waitcnt lgkmcnt(6)
    v_mfma_f32_32x32x16_bf16 v[60:75], v[100:103], v[92:95], v[60:75]
    ds_read_b128 v[124:127], v5 offset:33536
    ds_read_b64_tr_b16 v[132:133], v9 offset:16384
    ds_read_b64_tr_b16 v[134:135], v9 offset:16896
    v_cvt_pk_bf16_f32 v80, v84, v85
    v_cvt_pk_bf16_f32 v81, v86, v87
    v_cvt_pk_bf16_f32 v82, v88, v89
    v_mfma_f32_32x32x16_bf16 v[60:75], v[104:107], v[96:99], v[60:75]
    ds_read_b128 v[128:131], v6 offset:33536
    ds_read_b64_tr_b16 v[136:137], v10 offset:16384
    ds_read_b64_tr_b16 v[138:139], v10 offset:16896
    v_cvt_pk_bf16_f32 v83, v90, v91
    v_permlane32_swap_b32 v76, v78
    v_mfma_f32_16x16x32_bf16 v[28:31], v[24:27], v[100:103], v[28:31]
    s_waitcnt lgkmcnt(6)
    v_mfma_f32_32x32x16_bf16 v[60:75], v[116:119], v[108:111], v[60:75]
    ds_read_b128 v[92:95], v5 offset:33600
    ds_read_b64_tr_b16 v[100:101], v9 offset:20480
    ds_read_b64_tr_b16 v[102:103], v9 offset:20992
    v_permlane32_swap_b32 v77, v79
    buffer_store_dwordx4 v[76:79], v14, s[20:23], s44 offen offset:1024 sc1
    v_permlane32_swap_b32 v80, v82
    v_mfma_f32_32x32x16_bf16 v[60:75], v[120:123], v[112:115], v[60:75]
    ds_read_b128 v[96:99], v6 offset:33600
    ds_read_b64_tr_b16 v[104:105], v10 offset:20480
    ds_read_b64_tr_b16 v[106:107], v10 offset:20992
    v_permlane32_swap_b32 v81, v83
    buffer_store_dwordx4 v[80:83], v14, s[20:23], s44 offen offset:1536 sc1
    v_mfma_f32_16x16x32_bf16 v[28:31], v[24:27], v[116:119], v[28:31]
    s_waitcnt lgkmcnt(6)
    v_mfma_f32_32x32x16_bf16 v[60:75], v[132:135], v[124:127], v[60:75]
    ds_read_b128 v[108:111], v7 offset:33664
    ds_read_b64_tr_b16 v[116:117], v9 offset:24576
    ds_read_b64_tr_b16 v[118:119], v9 offset:25088
    ds_read_b64 v[22:23], v22
    v_mfma_f32_32x32x16_bf16 v[60:75], v[136:139], v[128:131], v[60:75]
    ds_read_b128 v[112:115], v8 offset:33664
    ds_read_b64_tr_b16 v[120:121], v10 offset:24576
    ds_read_b64_tr_b16 v[122:123], v10 offset:25088
    v_mfma_f32_16x16x32_bf16 v[28:31], v[24:27], v[132:135], v[28:31]
    s_waitcnt lgkmcnt(7)
    v_mfma_f32_32x32x16_bf16 v[60:75], v[100:103], v[92:95], v[60:75]
    ds_read_b128 v[124:127], v7 offset:33728
    ds_read_b64_tr_b16 v[132:133], v9 offset:28672
    ds_read_b64_tr_b16 v[134:135], v9 offset:29184
    v_mfma_f32_32x32x16_bf16 v[60:75], v[104:107], v[96:99], v[60:75]
    ds_read_b128 v[128:131], v8 offset:33728
    ds_read_b64_tr_b16 v[136:137], v10 offset:28672
    ds_read_b64_tr_b16 v[138:139], v10 offset:29184
    v_mfma_f32_16x16x32_bf16 v[28:31], v[24:27], v[100:103], v[28:31]
    s_waitcnt lgkmcnt(6)
    v_mfma_f32_32x32x16_bf16 v[60:75], v[116:119], v[108:111], v[60:75]
    v_mfma_f32_32x32x16_bf16 v[60:75], v[120:123], v[112:115], v[60:75]
    v_mfma_f32_16x16x32_bf16 v[28:31], v[24:27], v[116:119], v[28:31]
    s_waitcnt lgkmcnt(0)
    v_mfma_f32_32x32x16_bf16 v[60:75], v[132:135], v[124:127], v[60:75]
    v_mfma_f32_32x32x16_bf16 v[60:75], v[136:139], v[128:131], v[60:75]
    v_mfma_f32_16x16x32_bf16 v[28:31], v[24:27], v[132:135], v[28:31]
    v_readfirstlane_b32 s84, v22
    v_readfirstlane_b32 s85, v23
    s_nop 5
    ds_write_b32 v15, v28 offset:2048
    s_waitcnt lgkmcnt(0)
    s_barrier
    ds_read_b32 v18, v19 offset:2048
    s_waitcnt lgkmcnt(0)
    v_add_f32 v18, v18, v28
    v_cvt_pk_bf16_f32 v4, v18, v18
    v_lshlrev_b32 v4, 16, v4
    v_sub_f32 v4, v18, v4
    v_cvt_pk_bf16_f32 v40, v18, v4
    s_nop 1
    v_mfma_f32_32x32x16_bf16 v[60:75], v[40:43], v[36:39], v[60:75]
    s_nop 7
    s_nop 3
    v_pk_mul_f32 v[60:61], v[60:61], v[20:21] op_sel:[0,1]
    v_pk_mul_f32 v[62:63], v[62:63], v[20:21] op_sel:[0,1]
    v_pk_mul_f32 v[64:65], v[64:65], v[20:21] op_sel:[0,1]
    v_pk_mul_f32 v[66:67], v[66:67], v[20:21] op_sel:[0,1]
    v_cvt_pk_bf16_f32 v60, v60, v61
    v_cvt_pk_bf16_f32 v61, v62, v63
    v_cvt_pk_bf16_f32 v62, v64, v65
    v_cvt_pk_bf16_f32 v63, v66, v67
    buffer_store_dwordx4 v[60:63], v3, s[20:23], s42 offen sc1
    v_pk_mul_f32 v[68:69], v[68:69], v[20:21] op_sel:[0,1]
    v_pk_mul_f32 v[70:71], v[70:71], v[20:21] op_sel:[0,1]
    v_pk_mul_f32 v[72:73], v[72:73], v[20:21] op_sel:[0,1]
    v_pk_mul_f32 v[74:75], v[74:75], v[20:21] op_sel:[0,1]
    v_cvt_pk_bf16_f32 v64, v68, v69
    v_cvt_pk_bf16_f32 v65, v70, v71
    v_cvt_pk_bf16_f32 v66, v72, v73
    v_cvt_pk_bf16_f32 v67, v74, v75
    buffer_store_dwordx4 v[64:67], v3, s[20:23], s43 offen sc1
    s_mov_b32 s62, 0x1780000
    v_mov_b32 v22, s84
    v_mov_b32 v23, s85
    s_mov_b64 exec, 0xffff
    s_waitcnt vmcnt(0)
    buffer_store_dwordx2 v[22:23], v13, s[20:23], s62 offen sc1
    s_mov_b64 exec, -1
    s_barrier
sequential_preLN__softmax_full_mha__geglu_ffn__prompt_kernel_p1_done:
    s_branch sequential_preLN__softmax_full_mha__geglu_ffn__prompt_kernel_p2_comp
.p2align 12
sequential_preLN__softmax_full_mha__geglu_ffn__prompt_kernel_pg_rs:
sequential_preLN__softmax_full_mha__geglu_ffn__prompt_kernel_role_s:
    s_and_b32 s47, s2, 1
    s_lshl_b32 s47, s47, 3
    s_lshr_b32 s62, s2, 5
    s_add_u32 s47, s47, s62
    s_and_b32 s29, s24, 3
    s_lshl_b32 s27, s29, 10
    s_add_u32 s27, s27, 101376
    v_add_u32 v6, s27, v3
    v_and_b32 v38, 31, v0
    v_lshl_add_u32 v38, v38, 2, s27
    v_mov_b32 v28, 0
    v_mov_b32 v29, 0
    s_and_b32 s30, s2, 6
    s_lshl_b32 s30, s30, 1
    s_bfe_u32 s27, s2, 0x20003
    s_add_u32 s30, s30, s27
    s_lshl_b32 s30, s30, 2
    s_add_u32 s30, s30, s29
    s_lshl_b32 s30, s30, 12
    s_add_u32 s30, s30, 0xa00000
    v_and_b32 v7, 0x1ff, v3
    s_lshl_b32 s27, s29, 9
    s_add_u32 s27, s27, 98304
    v_add_u32 v7, s27, v7
    s_setprio 3
    s_barrier
    s_barrier
    s_barrier
    s_lshl_b32 s27, s2, 4
    s_add_u32 s27, s27, s24
    s_cmp_lg_u32 s27, 9
    s_cbranch_scc1 sequential_preLN__softmax_full_mha__geglu_ffn__prompt_kernel_rs_norst
    s_mov_b64 s[12:13], s[80:81]
    s_mov_b32 s14, 0x100
    s_mov_b32 s15, 0x00020000
    buffer_store_dwordx2 v[28:29], v28, s[12:15], 0 offen sc1
sequential_preLN__softmax_full_mha__geglu_ffn__prompt_kernel_rs_norst:
    s_barrier
    s_barrier
    s_barrier
    s_barrier
    s_barrier
    s_barrier
    s_barrier
    s_cmp_ge_u32 s47, 15
    s_cbranch_scc1 sequential_preLN__softmax_full_mha__geglu_ffn__prompt_kernel_rs_empty
    v_lshlrev_b32 v1, 3, v0
    s_lshl_b32 s61, s2, 9
    s_add_u32 s61, s61, 0x17c0000
    s_cmp_lg_u32 s24, 8
    s_barrier
    s_cbranch_scc1 sequential_preLN__softmax_full_mha__geglu_ffn__prompt_kernel_rs_nop_h
    s_mov_b32 s63, 0x40000
sequential_preLN__softmax_full_mha__geglu_ffn__prompt_kernel_rs_poll_h:
    v_mov_b32 v4, 0
    v_mov_b32 v5, 0
    buffer_atomic_or_x2 v[4:5], v1, s[20:23], s61 offen sc0 sc1
    s_sub_u32 s63, s63, 1
    s_waitcnt vmcnt(0)
    v_cmp_ne_u64 vcc, s[84:85], v[4:5]
    s_cbranch_scc1 sequential_preLN__softmax_full_mha__geglu_ffn__prompt_kernel_rs_polld_h
    s_cbranch_vccz sequential_preLN__softmax_full_mha__geglu_ffn__prompt_kernel_rs_polld_h
    s_mov_b64 exec, vcc
    s_sleep 1
    s_branch sequential_preLN__softmax_full_mha__geglu_ffn__prompt_kernel_rs_poll_h
sequential_preLN__softmax_full_mha__geglu_ffn__prompt_kernel_rs_polld_h:
    s_mov_b64 exec, -1
sequential_preLN__softmax_full_mha__geglu_ffn__prompt_kernel_rs_nop_h:
    s_barrier
    s_barrier
    s_barrier
    buffer_load_dwordx4 v[8:11], v3, s[20:23], s30 offen offset:0 sc1
    buffer_load_dwordx4 v[12:15], v3, s[20:23], s30 offen offset:1024 sc1
    buffer_load_dwordx4 v[16:19], v3, s[20:23], s30 offen offset:2048 sc1
    buffer_load_dwordx4 v[20:23], v3, s[20:23], s30 offen offset:3072 sc1
    s_barrier
    s_barrier
    s_waitcnt vmcnt(0)
    v_add_f32 v8, v8, v12
    v_add_f32 v9, v9, v13
    v_add_f32 v10, v10, v14
    v_add_f32 v11, v11, v15
    v_add_f32 v8, v8, v16
    v_add_f32 v9, v9, v17
    v_add_f32 v10, v10, v18
    v_add_f32 v11, v11, v19
    v_add_f32 v8, v8, v20
    v_add_f32 v9, v9, v21
    v_add_f32 v10, v10, v22
    v_add_f32 v11, v11, v23
    ds_write_b128 v6, v[8:11]
    s_waitcnt lgkmcnt(0)
    ds_read2_b32 v[8:9], v38 offset0:0 offset1:32
    ds_read2_b32 v[10:11], v38 offset0:64 offset1:96
    ds_read2_b32 v[12:13], v38 offset0:128 offset1:160
    ds_read2_b32 v[14:15], v38 offset0:192 offset1:224
    s_waitcnt lgkmcnt(0)
    v_add_f32 v28, v8, v10
    v_add_f32 v29, v9, v11
    v_add_f32 v28, v28, v12
    v_add_f32 v29, v29, v13
    v_add_f32 v28, v28, v14
    v_add_f32 v29, v29, v15
    s_barrier
    v_mul_f32 v28, 0x3b000000, v28
    v_mul_f32 v29, 0x3b000000, v29
    v_fma_f32 v29, -v28, v28, v29
    v_max_f32 v29, 0, v29
    v_cvt_pk_bf16_f32 v32, -v28, -v28
    v_cvt_pk_bf16_f32 v36, v29, v29
    v_lshlrev_b32 v36, 16, v36
    v_add_f32 v36, 0x3727c5ac, v36
    v_cvt_pk_bf16_f32 v36, v36, v36
    v_lshlrev_b32 v36, 16, v36
    v_sqrt_f32 v36, v36
    s_nop 0
    v_cvt_pk_bf16_f32 v36, v36, v36
    v_lshlrev_b32 v36, 16, v36
    v_rcp_f32 v37, v36
    s_nop 0
    v_mul_f32 v35, v36, v36
    v_mul_f32 v33, 0xc0135761, v37
    v_mul_f32 v34, v37, v37
    v_mul_f32 v34, v34, v33
    v_mul_f32 v34, 0x3d372713, v34
    ds_write_b128 v7, v[32:35]
    s_waitcnt lgkmcnt(0)
    s_barrier
    s_barrier
    s_barrier
sequential_preLN__softmax_full_mha__geglu_ffn__prompt_kernel_rs_empty:
    s_barrier
    v_lshlrev_b32 v1, 3, v0
    s_lshl_b32 s61, s2, 9
    s_add_u32 s61, s61, 0x17e0000
    s_cmp_lg_u32 s24, 8
    s_barrier
    s_cbranch_scc1 sequential_preLN__softmax_full_mha__geglu_ffn__prompt_kernel_rs_nop_act
    s_mov_b64 exec, 0x3fffffff
    s_mov_b32 s63, 0x40000
sequential_preLN__softmax_full_mha__geglu_ffn__prompt_kernel_rs_poll_act:
    v_mov_b32 v4, 0
    v_mov_b32 v5, 0
    buffer_atomic_or_x2 v[4:5], v1, s[20:23], s61 offen sc0 sc1
    s_sub_u32 s63, s63, 1
    s_waitcnt vmcnt(0)
    v_cmp_ne_u64 vcc, s[84:85], v[4:5]
    s_cbranch_scc1 sequential_preLN__softmax_full_mha__geglu_ffn__prompt_kernel_rs_polld_act
    s_cbranch_vccz sequential_preLN__softmax_full_mha__geglu_ffn__prompt_kernel_rs_polld_act
    s_mov_b64 exec, vcc
    s_sleep 1
    s_branch sequential_preLN__softmax_full_mha__geglu_ffn__prompt_kernel_rs_poll_act
sequential_preLN__softmax_full_mha__geglu_ffn__prompt_kernel_rs_polld_act:
    s_mov_b64 exec, -1
sequential_preLN__softmax_full_mha__geglu_ffn__prompt_kernel_rs_nop_act:
    s_barrier
    s_branch sequential_preLN__softmax_full_mha__geglu_ffn__prompt_kernel_fin
sequential_preLN__softmax_full_mha__geglu_ffn__prompt_kernel_p2_comp:
    v_lshlrev_b32 v3, 4, v0
    s_and_b32 s25, s2, 7
    s_lshl_b32 s25, s25, 2
    s_bfe_u32 s27, s2, 0x20003
    s_add_u32 s25, s25, s27
    s_lshr_b32 s26, s2, 5
    s_sub_u32 s46, s24, 4
    s_lshl_b32 s26, s26, 3
    s_add_u32 s26, s26, s46
    v_lshrrev_b32 v2, 5, v0
    v_mov_b32 v4, v3
    v_lshlrev_b32 v5, 8, v2
    v_and_b32 v1, 15, v0
    v_lshl_add_u32 v5, v1, 4, v5
    v_mov_b32 v1, 0x3f803f80
    v_and_b32 v10, 11, v0
    v_cmp_eq_u32 vcc, 0, v10
    s_lshl_b32 s27, s46, 10
    s_add_u32 s27, s27, 131072
    v_cndmask_b32 v1, 0, v1, vcc
    v_add_u32 v10, s27, v3
    v_mov_b32 v28, v1
    v_mov_b32 v29, v1
    v_mov_b32 v30, v1
    v_mov_b32 v31, v1
    v_mov_b32 v32, v1
    v_mov_b32 v33, v1
    v_mov_b32 v34, v1
    v_mov_b32 v35, v1
    v_mov_b32 v36, v1
    v_mov_b32 v37, v1
    v_mov_b32 v38, v1
    v_mov_b32 v39, v1
    v_mov_b32 v40, v1
    v_mov_b32 v41, v1
    v_mov_b32 v42, v1
    v_mov_b32 v43, v1
    v_pk_mov_b32 v[84:85], 0, 0
    v_pk_mov_b32 v[86:87], 0, 0
    v_pk_mov_b32 v[88:89], 0, 0
    v_pk_mov_b32 v[90:91], 0, 0
    v_pk_mov_b32 v[92:93], 0, 0
    v_pk_mov_b32 v[94:95], 0, 0
    v_pk_mov_b32 v[96:97], 0, 0
    v_pk_mov_b32 v[98:99], 0, 0
    v_pk_mov_b32 v[100:101], 0, 0
    v_pk_mov_b32 v[102:103], 0, 0
    v_pk_mov_b32 v[104:105], 0, 0
    v_pk_mov_b32 v[106:107], 0, 0
    v_mov_b32 v8, 0xdddddddd
    s_mov_b32 s42, 0x0000ffff
    s_mov_b32 s43, 0x0000ffff
    s_mov_b32 s44, 0
    s_mov_b32 s45, 0
    v_mov_b32 v6, 161792
    s_lshr_b32 s27, s26, 1
    s_lshl_b32 s27, s27, 5
    s_add_u32 s27, s27, s25
    s_lshl_b32 s27, s27, 1
    s_and_b32 s28, s26, 1
    s_add_u32 s27, s27, s28
    s_lshl_b32 s27, s27, 10
    s_add_u32 s47, s27, 0x600000
    s_lshr_b32 s27, s26, 1
    s_lshl_b32 s29, s25, 1
    s_add_u32 s28, s28, s29
    v_lshlrev_b32 v7, 14, v0
    s_lshr_b32 s62, s27, 2
    s_lshl_b32 s62, s62, 9
    s_and_b32 s63, s27, 3
    s_lshl_b32 s63, s63, 12
    s_add_u32 s62, s62, s63
    s_lshl_b32 s63, s28, 3
    s_add_u32 s62, s62, s63
    v_add_u32 v7, s62, v7
    s_barrier
    s_barrier
    ds_read_b128 v[16:19], v10
    ds_read_b128 v[20:23], v4
    s_waitcnt lgkmcnt(0)
    v_mfma_f32_32x32x16_bf16 v[60:75], v[20:23], v[16:19], 0
    s_barrier
    s_nop 7
    s_nop 2
    v_max3_f32 v1, v60, v61, v62
    v_max3_f32 v1, v1, v63, v64
    v_max3_f32 v1, v1, v65, v66
    v_max3_f32 v1, v1, v67, v68
    v_max3_f32 v1, v1, v69, v70
    v_max3_f32 v1, v1, v71, v72
    v_max3_f32 v1, v1, v73, v74
    v_max_f32 v1, v1, v75
sequential_preLN__softmax_full_mha__geglu_ffn__prompt_kernel_p2_setm:
    ds_read_b128 v[24:27], v4 offset:2048
    s_mov_b64 exec, s[42:43]
    ds_read_b128 v[28:31], v5 offset:1024
    ds_read_b128 v[32:35], v5 offset:1536
    s_mov_b64 exec, -1
    v_mov_b32 v2, v1
    s_nop 1
    v_permlane32_swap_b32 v1, v2
    v_max_f32 v1, v1, v2
    v_sub_f32 v44, 0, v1
    v_sub_f32 v45, 0, v1
    v_pk_mov_b32 v[46:47], v[44:45], v[44:45]
    v_pk_mov_b32 v[48:49], v[44:45], v[44:45]
    v_pk_mov_b32 v[50:51], v[44:45], v[44:45]
    v_pk_mov_b32 v[52:53], v[44:45], v[44:45]
    v_pk_mov_b32 v[54:55], v[44:45], v[44:45]
    v_pk_mov_b32 v[56:57], v[44:45], v[44:45]
    v_pk_mov_b32 v[58:59], v[44:45], v[44:45]
    s_nop 1
    v_mfma_f32_32x32x16_bf16 v[60:75], v[20:23], v[16:19], v[44:59]
    s_mov_b32 s41, 0
    s_nop 7
    s_nop 1
sequential_preLN__softmax_full_mha__geglu_ffn__prompt_kernel_p2_loop:
    s_setprio 3
    v_exp_f32 v60, v60
    v_exp_f32 v61, v61
    v_exp_f32 v62, v62
    v_smfmac_f32_32x32x32_bf16 v[92:107], v[40:43], v[84:91], v8
    v_exp_f32 v63, v63
    v_exp_f32 v64, v64
    v_exp_f32 v65, v65
    v_exp_f32 v66, v66
    v_exp_f32 v67, v67
    s_waitcnt lgkmcnt(2)
    v_mfma_f32_32x32x16_bf16 v[76:91], v[24:27], v[16:19], v[44:59]
    ds_read_b128 v[20:23], v4 offset:4096
    v_exp_f32 v68, v68
    v_exp_f32 v69, v69
    v_exp_f32 v70, v70
    v_exp_f32 v71, v71
    v_exp_f32 v72, v72
    s_waitcnt lgkmcnt(1)
    v_smfmac_f32_32x32x32_bf16 v[92:107], v[28:31], v[60:67], v8
    s_mov_b64 exec, s[42:43]
    ds_read_b128 v[36:39], v5 offset:3072
    ds_read_b128 v[40:43], v5 offset:3584
    s_mov_b64 exec, -1
    v_exp_f32 v73, v73
    v_exp_f32 v74, v74
    v_exp_f32 v75, v75
    v_exp_f32 v76, v76
    v_exp_f32 v77, v77
    v_exp_f32 v78, v78
    v_smfmac_f32_32x32x32_bf16 v[92:107], v[32:35], v[68:75], v8
    v_exp_f32 v79, v79
    v_exp_f32 v80, v80
    v_exp_f32 v81, v81
    v_exp_f32 v82, v82
    v_exp_f32 v83, v83
    s_waitcnt lgkmcnt(2)
    v_mfma_f32_32x32x16_bf16 v[60:75], v[20:23], v[16:19], v[44:59]
    ds_read_b128 v[24:27], v4 offset:6144
    v_exp_f32 v84, v84
    v_exp_f32 v85, v85
    v_exp_f32 v86, v86
    v_exp_f32 v87, v87
    v_exp_f32 v88, v88
    s_waitcnt lgkmcnt(1)
    v_smfmac_f32_32x32x32_bf16 v[92:107], v[36:39], v[76:83], v8
    s_mov_b64 exec, s[42:43]
    ds_read_b128 v[28:31], v5 offset:5120
    ds_read_b128 v[32:35], v5 offset:5632
    s_mov_b64 exec, -1
    v_exp_f32 v89, v89
    v_exp_f32 v90, v90
    v_exp_f32 v91, v91
    s_setprio 2
    v_exp_f32 v60, v60
    v_exp_f32 v61, v61
    v_exp_f32 v62, v62
    v_smfmac_f32_32x32x32_bf16 v[92:107], v[40:43], v[84:91], v8
    v_exp_f32 v63, v63
    v_exp_f32 v64, v64
    v_exp_f32 v65, v65
    v_exp_f32 v66, v66
    v_exp_f32 v67, v67
    s_waitcnt lgkmcnt(2)
    v_mfma_f32_32x32x16_bf16 v[76:91], v[24:27], v[16:19], v[44:59]
    ds_read_b128 v[20:23], v4 offset:8192
    v_exp_f32 v68, v68
    v_exp_f32 v69, v69
    v_exp_f32 v70, v70
    v_exp_f32 v71, v71
    v_exp_f32 v72, v72
    s_waitcnt lgkmcnt(1)
    v_smfmac_f32_32x32x32_bf16 v[92:107], v[28:31], v[60:67], v8
    s_mov_b64 exec, s[42:43]
    ds_read_b128 v[36:39], v5 offset:7168
    ds_read_b128 v[40:43], v5 offset:7680
    s_mov_b64 exec, -1
    v_exp_f32 v73, v73
    v_exp_f32 v74, v74
    v_exp_f32 v75, v75
    v_exp_f32 v76, v76
    v_exp_f32 v77, v77
    v_exp_f32 v78, v78
    v_smfmac_f32_32x32x32_bf16 v[92:107], v[32:35], v[68:75], v8
    v_exp_f32 v79, v79
    v_exp_f32 v80, v80
    v_exp_f32 v81, v81
    v_exp_f32 v82, v82
    v_exp_f32 v83, v83
    s_waitcnt lgkmcnt(2)
    v_mfma_f32_32x32x16_bf16 v[60:75], v[20:23], v[16:19], v[44:59]
    ds_read_b128 v[24:27], v4 offset:10240
    v_exp_f32 v84, v84
    v_exp_f32 v85, v85
    v_exp_f32 v86, v86
    v_exp_f32 v87, v87
    v_exp_f32 v88, v88
    s_waitcnt lgkmcnt(1)
    v_smfmac_f32_32x32x32_bf16 v[92:107], v[36:39], v[76:83], v8
    s_mov_b64 exec, s[42:43]
    ds_read_b128 v[28:31], v5 offset:9216
    ds_read_b128 v[32:35], v5 offset:9728
    s_mov_b64 exec, -1
    v_exp_f32 v89, v89
    v_exp_f32 v90, v90
    v_exp_f32 v91, v91
    s_setprio 1
    v_exp_f32 v60, v60
    v_exp_f32 v61, v61
    v_exp_f32 v62, v62
    v_smfmac_f32_32x32x32_bf16 v[92:107], v[40:43], v[84:91], v8
    v_exp_f32 v63, v63
    v_exp_f32 v64, v64
    v_exp_f32 v65, v65
    v_exp_f32 v66, v66
    v_exp_f32 v67, v67
    s_waitcnt lgkmcnt(2)
    v_mfma_f32_32x32x16_bf16 v[76:91], v[24:27], v[16:19], v[44:59]
    ds_read_b128 v[20:23], v4 offset:12288
    v_exp_f32 v68, v68
    v_exp_f32 v69, v69
    v_exp_f32 v70, v70
    v_exp_f32 v71, v71
    v_exp_f32 v72, v72
    s_waitcnt lgkmcnt(1)
    v_smfmac_f32_32x32x32_bf16 v[92:107], v[28:31], v[60:67], v8
    s_mov_b64 exec, s[42:43]
    ds_read_b128 v[36:39], v5 offset:11264
    ds_read_b128 v[40:43], v5 offset:11776
    s_mov_b64 exec, -1
    v_exp_f32 v73, v73
    v_exp_f32 v74, v74
    v_exp_f32 v75, v75
    v_exp_f32 v76, v76
    v_exp_f32 v77, v77
    v_exp_f32 v78, v78
    v_smfmac_f32_32x32x32_bf16 v[92:107], v[32:35], v[68:75], v8
    v_exp_f32 v79, v79
    v_exp_f32 v80, v80
    v_exp_f32 v81, v81
    v_exp_f32 v82, v82
    v_exp_f32 v83, v83
    s_waitcnt lgkmcnt(2)
    v_mfma_f32_32x32x16_bf16 v[60:75], v[20:23], v[16:19], v[44:59]
    ds_read_b128 v[24:27], v4 offset:14336
    v_exp_f32 v84, v84
    v_exp_f32 v85, v85
    v_exp_f32 v86, v86
    v_exp_f32 v87, v87
    v_exp_f32 v88, v88
    s_waitcnt lgkmcnt(1)
    v_smfmac_f32_32x32x32_bf16 v[92:107], v[36:39], v[76:83], v8
    s_mov_b64 exec, s[42:43]
    ds_read_b128 v[28:31], v5 offset:13312
    ds_read_b128 v[32:35], v5 offset:13824
    s_mov_b64 exec, -1
    v_exp_f32 v89, v89
    v_exp_f32 v90, v90
    v_exp_f32 v91, v91
    s_setprio 0
    s_add_u32 s27, s41, 2
    s_cmp_lt_u32 s44, s27
    s_cbranch_scc1 sequential_preLN__softmax_full_mha__geglu_ffn__prompt_kernel_p2_chk
sequential_preLN__softmax_full_mha__geglu_ffn__prompt_kernel_p2_back:
    v_exp_f32 v60, v60
    v_exp_f32 v61, v61
    v_exp_f32 v62, v62
    v_smfmac_f32_32x32x32_bf16 v[92:107], v[40:43], v[84:91], v8
    v_exp_f32 v63, v63
    v_exp_f32 v64, v64
    v_exp_f32 v65, v65
    v_exp_f32 v66, v66
    v_exp_f32 v67, v67
    s_waitcnt lgkmcnt(2)
    v_mfma_f32_32x32x16_bf16 v[76:91], v[24:27], v[16:19], v[44:59]
    ds_read_b128 v[20:23], v4 offset:16384
    v_exp_f32 v68, v68
    v_exp_f32 v69, v69
    v_exp_f32 v70, v70
    v_exp_f32 v71, v71
    v_exp_f32 v72, v72
    s_waitcnt lgkmcnt(1)
    v_smfmac_f32_32x32x32_bf16 v[92:107], v[28:31], v[60:67], v8
    s_mov_b64 exec, s[42:43]
    ds_read_b128 v[36:39], v5 offset:15360
    ds_read_b128 v[40:43], v5 offset:15872
    s_mov_b64 exec, -1
    v_exp_f32 v73, v73
    v_exp_f32 v74, v74
    v_exp_f32 v75, v75
    v_exp_f32 v76, v76
    v_exp_f32 v77, v77
    v_exp_f32 v78, v78
    v_smfmac_f32_32x32x32_bf16 v[92:107], v[32:35], v[68:75], v8
    v_exp_f32 v79, v79
    v_exp_f32 v80, v80
    v_exp_f32 v81, v81
    v_exp_f32 v82, v82
    v_exp_f32 v83, v83
    s_waitcnt lgkmcnt(2)
    v_mfma_f32_32x32x16_bf16 v[60:75], v[20:23], v[16:19], v[44:59]
    ds_read_b128 v[24:27], v4 offset:18432
    v_exp_f32 v84, v84
    v_exp_f32 v85, v85
    v_exp_f32 v86, v86
    v_exp_f32 v87, v87
    v_exp_f32 v88, v88
    s_waitcnt lgkmcnt(1)
    v_smfmac_f32_32x32x32_bf16 v[92:107], v[36:39], v[76:83], v8
    s_mov_b64 exec, s[42:43]
    ds_read_b128 v[28:31], v5 offset:17408
    ds_read_b128 v[32:35], v5 offset:17920
    s_mov_b64 exec, -1
    v_add_u32 v4, 0x4000, v4
    v_add_u32 v5, 0x4000, v5
    s_add_u32 s41, s41, 1
    s_cmp_lt_u32 s41, 8
    v_exp_f32 v89, v89
    v_exp_f32 v90, v90
    v_exp_f32 v91, v91
    s_cbranch_scc1 sequential_preLN__softmax_full_mha__geglu_ffn__prompt_kernel_p2_loop
    s_nop 0
    v_smfmac_f32_32x32x32_bf16 v[92:107], v[40:43], v[84:91], v8
    s_waitcnt lgkmcnt(0)
    v_mov_b32 v2, 0x5d800000
    s_nop 7
    s_nop 1
    v_cmp_nlt_f32 vcc, v100, v2
    v_rcp_f32 v1, v100
    s_cbranch_vccz sequential_preLN__softmax_full_mha__geglu_ffn__prompt_kernel_p2_fin
    s_cmp_lg_u32 s45, 0
    s_cbranch_scc1 sequential_preLN__softmax_full_mha__geglu_ffn__prompt_kernel_p2_fin
    s_mov_b32 s45, 1
    v_mov_b32 v4, v3
    v_subrev_u32 v5, 0x20000, v5
    v_mov_b32 v1, 0xff800000
    v_pk_mov_b32 v[84:85], 0, 0
    v_pk_mov_b32 v[86:87], 0, 0
    v_pk_mov_b32 v[88:89], 0, 0
    v_pk_mov_b32 v[90:91], 0, 0
    v_pk_mov_b32 v[92:93], 0, 0
    v_pk_mov_b32 v[94:95], 0, 0
    v_pk_mov_b32 v[96:97], 0, 0
    v_pk_mov_b32 v[98:99], 0, 0
    v_pk_mov_b32 v[100:101], 0, 0
    v_pk_mov_b32 v[102:103], 0, 0
    v_pk_mov_b32 v[104:105], 0, 0
    v_pk_mov_b32 v[106:107], 0, 0
    s_mov_b32 s41, 0
sequential_preLN__softmax_full_mha__geglu_ffn__prompt_kernel_p2_fbloop:
    ds_read_b128 v[20:23], v4
    v_add_u32 v4, 2048, v4
    s_waitcnt lgkmcnt(0)
    v_mfma_f32_32x32x16_bf16 v[60:75], v[20:23], v[16:19], 0
    s_add_u32 s41, s41, 1
    s_cmp_lt_u32 s41, 64
    s_nop 7
    s_nop 3
    v_max3_f32 v1, v1, v60, v61
    v_max3_f32 v1, v1, v62, v63
    v_max3_f32 v1, v1, v64, v65
    v_max3_f32 v1, v1, v66, v67
    v_max3_f32 v1, v1, v68, v69
    v_max3_f32 v1, v1, v70, v71
    v_max3_f32 v1, v1, v72, v73
    v_max3_f32 v1, v1, v74, v75
    s_cbranch_scc1 sequential_preLN__softmax_full_mha__geglu_ffn__prompt_kernel_p2_fbloop
    v_mov_b32 v4, v3
    ds_read_b128 v[20:23], v4
    s_waitcnt lgkmcnt(0)
    s_branch sequential_preLN__softmax_full_mha__geglu_ffn__prompt_kernel_p2_setm
sequential_preLN__softmax_full_mha__geglu_ffn__prompt_kernel_p2_chk:
    ds_read_b128 v[156:159], v6
    s_waitcnt lgkmcnt(0)
    v_min3_u32 v156, v156, v157, v158
    v_min_u32 v156, v156, v159
    s_nop 0
    v_readfirstlane_b32 s44, v156
    s_nop 0
    s_cmp_lt_u32 s44, s27
    s_cbranch_scc0 sequential_preLN__softmax_full_mha__geglu_ffn__prompt_kernel_p2_back
    s_sleep 1
    s_branch sequential_preLN__softmax_full_mha__geglu_ffn__prompt_kernel_p2_chk
sequential_preLN__softmax_full_mha__geglu_ffn__prompt_kernel_p2_fin:
    v_mul_f32 v92, v1, v92
    v_mul_f32 v93, v1, v93
    v_mul_f32 v94, v1, v94
    v_mul_f32 v95, v1, v95
    v_mul_f32 v96, v1, v96
    v_mul_f32 v97, v1, v97
    v_mul_f32 v98, v1, v98
    v_mul_f32 v99, v1, v99
    v_cvt_pk_bf16_f32 v92, v92, v93
    v_cvt_pk_bf16_f32 v93, v94, v95
    v_cvt_pk_bf16_f32 v94, v96, v97
    v_cvt_pk_bf16_f32 v95, v98, v99
    buffer_store_dwordx4 v[92:95], v3, s[20:23], s47 offen sc1
    s_barrier
    s_mov_b32 s62, 0x17a0000
    v_mov_b32 v12, s84
    v_mov_b32 v13, s85
    s_mov_b64 exec, 0xff
    s_waitcnt vmcnt(0)
    buffer_store_dwordx2 v[12:13], v7, s[20:23], s62 offen sc1
    s_mov_b64 exec, -1
    s_barrier
sequential_preLN__softmax_full_mha__geglu_ffn__prompt_kernel_p2_done:
    s_cmp_ge_u32 s24, 8
    s_cbranch_scc1 sequential_preLN__softmax_full_mha__geglu_ffn__prompt_kernel_role_s
    s_branch sequential_preLN__softmax_full_mha__geglu_ffn__prompt_kernel_pg_rc
.p2align 12
sequential_preLN__softmax_full_mha__geglu_ffn__prompt_kernel_pg_rc:
    s_and_b32 s25, s2, 7
    s_lshl_b32 s25, s25, 2
    s_bfe_u32 s27, s2, 0x20003
    s_add_u32 s25, s25, s27
    s_lshr_b32 s26, s2, 5
    s_and_b32 s47, s2, 1
    s_lshl_b32 s47, s47, 3
    s_lshr_b32 s62, s2, 5
    s_add_u32 s47, s47, s62
    s_and_b32 s33, s24, 1
    s_bfe_u32 s34, s24, 0x10001
    s_and_b32 s46, s24, 3
    s_mov_b32 s41, 0xffff0000
    s_lshl_b32 s27, s33, 10
    v_add_u32 v16, s27, v3
    v_and_b32 v19, 3, v0
    v_lshlrev_b32 v19, 3, v19
    v_lshrrev_b32 v20, 5, v0
    v_lshl_add_u32 v19, v20, 9, v19
    v_bfe_u32 v20, v0, 2, 2
    v_lshl_add_u32 v19, v20, 7, v19
    v_bfe_u32 v20, v0, 3, 1
    v_xor_b32 v20, s34, v20
    v_lshl_add_u32 v19, v20, 6, v19
    v_bfe_u32 v20, v0, 4, 1
    v_lshl_add_u32 v19, v20, 5, v19
    v_add_u32 v17, 0x10000, v16
    v_add_u32 v20, 0x10000, v19
    v_add_u32 v18, 0x20000, v16
    v_add_u32 v21, 0x20000, v19
    v_and_b32 v1, 31, v0
    v_lshrrev_b32 v2, 5, v0
    s_lshr_b32 s35, s25, 1
    s_lshl_b32 s35, s35, 5
    s_lshl_b32 s30, s26, 2
    s_add_u32 s35, s35, s30
    s_lshl_b32 s30, s34, 1
    s_add_u32 s35, s35, s30
    s_lshl_b32 s35, s35, 2
    s_and_b32 s30, s25, 1
    s_lshl_b32 s30, s30, 1
    s_add_u32 s35, s35, s30
    s_add_u32 s35, s35, s33
    s_lshl_b32 s35, s35, 10
    s_add_u32 s35, s35, 0x800000
    s_add_u32 s36, s35, 4096
    v_and_b32 v4, 7, v0
    s_lshl_b32 s27, s34, 2
    v_xor_b32 v24, s27, v4
    v_lshlrev_b32 v24, 4, v24
    v_lshl_add_u32 v24, v1, 7, v24
    v_lshl_add_u32 v24, v2, 3, v24
    s_lshl_b32 s27, s33, 12
    s_add_u32 s27, s27, 98304
    v_add_u32 v24, s27, v24
    v_xor_b32 v25, 16, v24
    v_xor_b32 v26, 32, v24
    v_xor_b32 v27, 48, v24
    v_lshlrev_b32 v7, 10, v1
    v_lshl_add_u32 v7, v2, 4, v7
    s_lshl_b32 s29, s25, 16
    s_lshl_b32 s30, s33, 15
    s_add_u32 s29, s29, s30
    s_lshl_b32 s30, s26, 7
    s_add_u32 s29, s29, s30
    s_lshl_b32 s30, s34, 6
    s_add_u32 s29, s29, s30
    s_mov_b64 s[12:13], s[78:79]
    s_mov_b32 s14, 0x200000
    s_mov_b32 s15, 0x00020000
    v_bfe_u32 v6, v0, 3, 1
    v_lshlrev_b32 v6, 9, v6
    v_lshl_add_u32 v6, v4, 14, v6
    s_lshr_b32 s27, s25, 3
    s_lshl_b32 s27, s27, 10
    s_bfe_u32 s28, s25, 0x20001
    s_lshl_b32 s28, s28, 12
    s_add_u32 s27, s27, s28
    s_and_b32 s28, s25, 1
    s_lshl_b32 s28, s28, 8
    s_add_u32 s27, s27, s28
    s_lshl_b32 s28, s26, 5
    s_add_u32 s27, s27, s28
    s_lshl_b32 s28, s46, 3
    s_add_u32 s27, s27, s28
    v_add_u32 v6, s27, v6
    s_lshl_b32 s37, s25, 1
    s_add_u32 s37, s37, s33
    s_lshl_b32 s37, s37, 12
    s_lshl_b32 s28, s26, 9
    s_add_u32 s37, s37, s28
    s_lshl_b32 s28, s34, 8
    s_add_u32 s37, s37, s28
    s_add_u32 s37, s37, 0xa00000
    s_mov_b32 s42, 0x3f803f80
    v_mov_b32 v1, 0
    v_mov_b32 v2, 0
    s_barrier
    s_barrier
    ds_read_b128 v[60:63], v16 offset:0
    ds_read_b64_tr_b16 v[76:77], v21 offset:0
    ds_read_b64_tr_b16 v[78:79], v21 offset:1024
    ds_read_b128 v[64:67], v16 offset:2048
    ds_read_b64_tr_b16 v[80:81], v21 offset:2048
    ds_read_b64_tr_b16 v[82:83], v21 offset:3072
    ds_read_b128 v[68:71], v16 offset:4096
    ds_read_b64_tr_b16 v[84:85], v21 offset:4096
    ds_read_b64_tr_b16 v[86:87], v21 offset:5120
    ds_read_b128 v[72:75], v16 offset:6144
    ds_read_b64_tr_b16 v[88:89], v21 offset:6144
    ds_read_b64_tr_b16 v[90:91], v21 offset:7168
    s_barrier
    ds_read_b128 v[92:95], v16 offset:8192
    ds_read_b64_tr_b16 v[108:109], v21 offset:8192
    ds_read_b64_tr_b16 v[110:111], v21 offset:9216
    s_waitcnt lgkmcnt(3)
    v_mfma_f32_32x32x16_bf16 v[28:43], v[76:79], v[60:63], 0
    ds_read_b128 v[96:99], v16 offset:10240
    ds_read_b64_tr_b16 v[112:113], v21 offset:10240
    ds_read_b64_tr_b16 v[114:115], v21 offset:11264
    v_mfma_f32_32x32x16_bf16 v[28:43], v[80:83], v[64:67], v[28:43]
    ds_read_b128 v[100:103], v16 offset:12288
    ds_read_b64_tr_b16 v[116:117], v21 offset:12288
    ds_read_b64_tr_b16 v[118:119], v21 offset:13312
    v_mfma_f32_32x32x16_bf16 v[28:43], v[84:87], v[68:71], v[28:43]
    ds_read_b128 v[104:107], v16 offset:14336
    ds_read_b64_tr_b16 v[120:121], v21 offset:14336
    ds_read_b64_tr_b16 v[122:123], v21 offset:15360
    v_mfma_f32_32x32x16_bf16 v[28:43], v[88:91], v[72:75], v[28:43]
    s_barrier
    ds_read_b128 v[60:63], v16 offset:16384
    ds_read_b64_tr_b16 v[76:77], v21 offset:16384
    ds_read_b64_tr_b16 v[78:79], v21 offset:17408
    s_waitcnt lgkmcnt(3)
    v_mfma_f32_32x32x16_bf16 v[28:43], v[108:111], v[92:95], v[28:43]
    ds_read_b128 v[64:67], v16 offset:18432
    ds_read_b64_tr_b16 v[80:81], v21 offset:18432
    ds_read_b64_tr_b16 v[82:83], v21 offset:19456
    v_mfma_f32_32x32x16_bf16 v[28:43], v[112:115], v[96:99], v[28:43]
    ds_read_b128 v[68:71], v16 offset:20480
    ds_read_b64_tr_b16 v[84:85], v21 offset:20480
    ds_read_b64_tr_b16 v[86:87], v21 offset:21504
    v_mfma_f32_32x32x16_bf16 v[28:43], v[116:119], v[100:103], v[28:43]
    ds_read_b128 v[72:75], v16 offset:22528
    ds_read_b64_tr_b16 v[88:89], v21 offset:22528
    ds_read_b64_tr_b16 v[90:91], v21 offset:23552
    v_mfma_f32_32x32x16_bf16 v[28:43], v[120:123], v[104:107], v[28:43]
    s_barrier
    ds_read_b128 v[92:95], v16 offset:24576
    ds_read_b64_tr_b16 v[108:109], v21 offset:24576
    ds_read_b64_tr_b16 v[110:111], v21 offset:25600
    s_waitcnt lgkmcnt(3)
    v_mfma_f32_32x32x16_bf16 v[28:43], v[76:79], v[60:63], v[28:43]
    ds_read_b128 v[96:99], v16 offset:26624
    ds_read_b64_tr_b16 v[112:113], v21 offset:26624
    ds_read_b64_tr_b16 v[114:115], v21 offset:27648
    v_mfma_f32_32x32x16_bf16 v[28:43], v[80:83], v[64:67], v[28:43]
    ds_read_b128 v[100:103], v16 offset:28672
    ds_read_b64_tr_b16 v[116:117], v21 offset:28672
    ds_read_b64_tr_b16 v[118:119], v21 offset:29696
    v_mfma_f32_32x32x16_bf16 v[28:43], v[84:87], v[68:71], v[28:43]
    ds_read_b128 v[104:107], v16 offset:30720
    ds_read_b64_tr_b16 v[120:121], v21 offset:30720
    ds_read_b64_tr_b16 v[122:123], v21 offset:31744
    v_mfma_f32_32x32x16_bf16 v[28:43], v[88:91], v[72:75], v[28:43]
    s_barrier
    ds_read_b128 v[60:63], v16 offset:32768
    ds_read_b64_tr_b16 v[76:77], v20 offset:0
    ds_read_b64_tr_b16 v[78:79], v20 offset:1024
    s_waitcnt lgkmcnt(3)
    v_mfma_f32_32x32x16_bf16 v[28:43], v[108:111], v[92:95], v[28:43]
    ds_read_b128 v[64:67], v16 offset:34816
    ds_read_b64_tr_b16 v[80:81], v20 offset:2048
    ds_read_b64_tr_b16 v[82:83], v20 offset:3072
    v_mfma_f32_32x32x16_bf16 v[28:43], v[112:115], v[96:99], v[28:43]
    ds_read_b128 v[68:71], v16 offset:36864
    ds_read_b64_tr_b16 v[84:85], v20 offset:4096
    ds_read_b64_tr_b16 v[86:87], v20 offset:5120
    v_mfma_f32_32x32x16_bf16 v[28:43], v[116:119], v[100:103], v[28:43]
    ds_read_b128 v[72:75], v16 offset:38912
    ds_read_b64_tr_b16 v[88:89], v20 offset:6144
    ds_read_b64_tr_b16 v[90:91], v20 offset:7168
    v_mfma_f32_32x32x16_bf16 v[28:43], v[120:123], v[104:107], v[28:43]
    s_barrier
    ds_read_b128 v[92:95], v16 offset:40960
    ds_read_b64_tr_b16 v[108:109], v20 offset:8192
    ds_read_b64_tr_b16 v[110:111], v20 offset:9216
    s_waitcnt lgkmcnt(3)
    v_mfma_f32_32x32x16_bf16 v[28:43], v[76:79], v[60:63], v[28:43]
    ds_read_b128 v[96:99], v16 offset:43008
    ds_read_b64_tr_b16 v[112:113], v20 offset:10240
    ds_read_b64_tr_b16 v[114:115], v20 offset:11264
    v_mfma_f32_32x32x16_bf16 v[28:43], v[80:83], v[64:67], v[28:43]
    ds_read_b128 v[100:103], v16 offset:45056
    ds_read_b64_tr_b16 v[116:117], v20 offset:12288
    ds_read_b64_tr_b16 v[118:119], v20 offset:13312
    v_mfma_f32_32x32x16_bf16 v[28:43], v[84:87], v[68:71], v[28:43]
    ds_read_b128 v[104:107], v16 offset:47104
    ds_read_b64_tr_b16 v[120:121], v20 offset:14336
    ds_read_b64_tr_b16 v[122:123], v20 offset:15360
    v_mfma_f32_32x32x16_bf16 v[28:43], v[88:91], v[72:75], v[28:43]
    s_barrier
    ds_read_b128 v[60:63], v16 offset:49152
    ds_read_b64_tr_b16 v[76:77], v20 offset:16384
    ds_read_b64_tr_b16 v[78:79], v20 offset:17408
    s_waitcnt lgkmcnt(3)
    v_mfma_f32_32x32x16_bf16 v[28:43], v[108:111], v[92:95], v[28:43]
    ds_read_b128 v[64:67], v16 offset:51200
    ds_read_b64_tr_b16 v[80:81], v20 offset:18432
    ds_read_b64_tr_b16 v[82:83], v20 offset:19456
    v_mfma_f32_32x32x16_bf16 v[28:43], v[112:115], v[96:99], v[28:43]
    ds_read_b128 v[68:71], v16 offset:53248
    ds_read_b64_tr_b16 v[84:85], v20 offset:20480
    ds_read_b64_tr_b16 v[86:87], v20 offset:21504
    v_mfma_f32_32x32x16_bf16 v[28:43], v[116:119], v[100:103], v[28:43]
    ds_read_b128 v[72:75], v16 offset:55296
    ds_read_b64_tr_b16 v[88:89], v20 offset:22528
    ds_read_b64_tr_b16 v[90:91], v20 offset:23552
    v_mfma_f32_32x32x16_bf16 v[28:43], v[120:123], v[104:107], v[28:43]
    s_barrier
    ds_read_b128 v[92:95], v16 offset:57344
    ds_read_b64_tr_b16 v[108:109], v20 offset:24576
    ds_read_b64_tr_b16 v[110:111], v20 offset:25600
    s_waitcnt lgkmcnt(3)
    v_mfma_f32_32x32x16_bf16 v[28:43], v[76:79], v[60:63], v[28:43]
    ds_read_b128 v[96:99], v16 offset:59392
    ds_read_b64_tr_b16 v[112:113], v20 offset:26624
    ds_read_b64_tr_b16 v[114:115], v20 offset:27648
    v_mfma_f32_32x32x16_bf16 v[28:43], v[80:83], v[64:67], v[28:43]
    ds_read_b128 v[100:103], v16 offset:61440
    ds_read_b64_tr_b16 v[116:117], v20 offset:28672
    ds_read_b64_tr_b16 v[118:119], v20 offset:29696
    v_mfma_f32_32x32x16_bf16 v[28:43], v[84:87], v[68:71], v[28:43]
    ds_read_b128 v[104:107], v16 offset:63488
    ds_read_b64_tr_b16 v[120:121], v20 offset:30720
    ds_read_b64_tr_b16 v[122:123], v20 offset:31744
    v_mfma_f32_32x32x16_bf16 v[28:43], v[88:91], v[72:75], v[28:43]
    s_waitcnt lgkmcnt(9)
    v_mfma_f32_32x32x16_bf16 v[28:43], v[108:111], v[92:95], v[28:43]
    ds_read_b64 v[8:9], v24
    ds_read_b64 v[10:11], v25
    ds_read_b64 v[12:13], v26
    ds_read_b64 v[14:15], v27
    s_waitcnt lgkmcnt(10)
    v_mfma_f32_32x32x16_bf16 v[28:43], v[112:115], v[96:99], v[28:43]
    s_waitcnt lgkmcnt(7)
    v_mfma_f32_32x32x16_bf16 v[28:43], v[116:119], v[100:103], v[28:43]
    s_waitcnt lgkmcnt(4)
    v_mfma_f32_32x32x16_bf16 v[28:43], v[120:123], v[104:107], v[28:43]
    s_waitcnt lgkmcnt(0)
    s_barrier
    v_lshlrev_b32 v44, 16, v8
    v_and_b32 v45, s41, v8
    v_lshlrev_b32 v46, 16, v9
    v_and_b32 v47, s41, v9
    v_lshlrev_b32 v48, 16, v10
    v_and_b32 v49, s41, v10
    v_lshlrev_b32 v50, 16, v11
    v_and_b32 v51, s41, v11
    v_lshlrev_b32 v52, 16, v12
    v_and_b32 v53, s41, v12
    v_lshlrev_b32 v54, 16, v13
    v_and_b32 v55, s41, v13
    v_lshlrev_b32 v56, 16, v14
    v_and_b32 v57, s41, v14
    v_lshlrev_b32 v58, 16, v15
    v_and_b32 v59, s41, v15
    v_cvt_pk_bf16_f32 v8, v28, v29
    v_cvt_pk_bf16_f32 v9, v30, v31
    v_cvt_pk_bf16_f32 v10, v32, v33
    v_cvt_pk_bf16_f32 v11, v34, v35
    v_cvt_pk_bf16_f32 v12, v36, v37
    v_cvt_pk_bf16_f32 v13, v38, v39
    v_cvt_pk_bf16_f32 v14, v40, v41
    v_cvt_pk_bf16_f32 v15, v42, v43
    v_lshlrev_b32 v28, 16, v8
    v_and_b32 v29, s41, v8
    v_lshlrev_b32 v30, 16, v9
    v_and_b32 v31, s41, v9
    v_lshlrev_b32 v32, 16, v10
    v_and_b32 v33, s41, v10
    v_lshlrev_b32 v34, 16, v11
    v_and_b32 v35, s41, v11
    v_lshlrev_b32 v36, 16, v12
    v_and_b32 v37, s41, v12
    v_lshlrev_b32 v38, 16, v13
    v_and_b32 v39, s41, v13
    v_lshlrev_b32 v40, 16, v14
    v_and_b32 v41, s41, v14
    v_lshlrev_b32 v42, 16, v15
    v_and_b32 v43, s41, v15
    v_pk_add_f32 v[28:29], v[28:29], v[44:45]
    v_pk_add_f32 v[30:31], v[30:31], v[46:47]
    v_pk_add_f32 v[32:33], v[32:33], v[48:49]
    v_pk_add_f32 v[34:35], v[34:35], v[50:51]
    v_pk_add_f32 v[36:37], v[36:37], v[52:53]
    v_pk_add_f32 v[38:39], v[38:39], v[54:55]
    v_pk_add_f32 v[40:41], v[40:41], v[56:57]
    v_pk_add_f32 v[42:43], v[42:43], v[58:59]
    v_cvt_pk_bf16_f32 v8, v28, v29
    v_cvt_pk_bf16_f32 v9, v30, v31
    v_cvt_pk_bf16_f32 v10, v32, v33
    v_cvt_pk_bf16_f32 v11, v34, v35
    v_cvt_pk_bf16_f32 v12, v36, v37
    v_cvt_pk_bf16_f32 v13, v38, v39
    v_cvt_pk_bf16_f32 v14, v40, v41
    v_cvt_pk_bf16_f32 v15, v42, v43
    buffer_store_dwordx4 v[8:11], v3, s[20:23], s35 offen sc1
    buffer_store_dwordx4 v[12:15], v3, s[20:23], s36 offen sc1
    v_dot2c_f32_bf16 v1, s42, v8
    v_dot2c_f32_bf16 v2, v8, v8
    v_dot2c_f32_bf16 v1, s42, v9
    v_dot2c_f32_bf16 v2, v9, v9
    v_dot2c_f32_bf16 v1, s42, v10
    v_dot2c_f32_bf16 v2, v10, v10
    v_dot2c_f32_bf16 v1, s42, v11
    v_dot2c_f32_bf16 v2, v11, v11
    v_dot2c_f32_bf16 v1, s42, v12
    v_dot2c_f32_bf16 v2, v12, v12
    v_dot2c_f32_bf16 v1, s42, v13
    v_dot2c_f32_bf16 v2, v13, v13
    v_dot2c_f32_bf16 v1, s42, v14
    v_dot2c_f32_bf16 v2, v14, v14
    v_dot2c_f32_bf16 v1, s42, v15
    v_dot2c_f32_bf16 v2, v15, v15
    v_lshlrev_b32 v24, 2, v0
    s_nop 1
    v_permlane32_swap_b32 v1, v2
    v_add_f32 v1, v1, v2
    buffer_store_dword v1, v24, s[20:23], s37 offen sc1
    s_mov_b32 s62, 0x17c0000
    v_mov_b32 v4, s84
    v_mov_b32 v5, s85
    s_mov_b64 exec, 0x7fff
    s_waitcnt vmcnt(0)
    buffer_store_dwordx2 v[4:5], v6, s[20:23], s62 offen sc1
    s_mov_b64 exec, -1
    s_barrier
    s_cmp_ge_u32 s47, 15
    s_cbranch_scc1 sequential_preLN__softmax_full_mha__geglu_ffn__prompt_kernel_rc_g4
    s_and_b32 s37, s2, 6
    s_lshl_b32 s37, s37, 1
    s_bfe_u32 s27, s2, 0x20003
    s_add_u32 s37, s37, s27
    s_lshl_b32 s27, s33, 11
    v_add_u32 v16, s27, v3
    s_mul_i32 s27, s34, 3072
    s_add_u32 s27, s27, 106496
    v_add_u32 v17, s27, v3
    v_subrev_u32 v18, 57344, v17
    s_mul_i32 s42, s47, 6
    s_mul_i32 s43, s34, 3
    s_add_u32 s42, s42, s43
    s_lshl_b32 s27, s37, 1
    s_add_u32 s27, s27, s33
    s_mul_i32 s45, s27, 86
    s_add_u32 s45, s45, s42
    s_lshl_b32 s45, s45, 11
    s_add_u32 s45, s45, 0x1200000
    s_lshl_b32 s28, s47, 1
    s_add_u32 s28, s28, s34
    v_lshlrev_b32 v6, 14, v0
    s_lshr_b32 s62, s27, 2
    s_lshl_b32 s62, s62, 9
    s_and_b32 s63, s27, 3
    s_lshl_b32 s63, s63, 12
    s_add_u32 s62, s62, s63
    s_lshl_b32 s63, s28, 3
    s_add_u32 s62, s62, s63
    v_add_u32 v6, s62, v6
    v_cmp_gt_u32 vcc, 32, v0
    v_and_b32 v1, 0x1ff, v3
    s_lshl_b32 s27, s33, 10
    s_add_u32 s27, s27, 98304
    v_add_u32 v1, s27, v1
    v_and_b32 v2, 31, v0
    s_mul_i32 s27, s34, 384
    s_add_u32 s27, s27, 100352
    v_lshl_add_u32 v2, v2, 2, s27
    s_branch sequential_preLN__softmax_full_mha__geglu_ffn__prompt_kernel_pad_gelu
sequential_preLN__softmax_full_mha__geglu_ffn__prompt_kernel_ret_gelu:
    s_branch sequential_preLN__softmax_full_mha__geglu_ffn__prompt_kernel_pg_c4
.p2align 12
sequential_preLN__softmax_full_mha__geglu_ffn__prompt_kernel_pg_c4:
    s_barrier
    s_barrier
    ds_read_b128 v[124:127], v17 offset:0
    ds_read_b128 v[116:119], v16 offset:0
    ds_read_b128 v[120:123], v16 offset:1024
    ds_read_b128 v[128:131], v17 offset:1024
    ds_read_b128 v[132:135], v17 offset:2048
    s_waitcnt lgkmcnt(0)
    v_mfma_f32_32x32x16_bf16 v[20:35], v[124:127], v[116:119], 0
    ds_read_b128 v[144:147], v17 offset:6144
    ds_read_b128 v[136:139], v16 offset:4096
    v_mfma_f32_32x32x16_bf16 v[68:83], v[124:127], v[120:123], 0
    ds_read_b128 v[140:143], v16 offset:5120
    ds_read_b128 v[148:151], v17 offset:7168
    v_mfma_f32_32x32x16_bf16 v[36:51], v[128:131], v[116:119], 0
    ds_read_b128 v[152:155], v17 offset:8192
    v_mfma_f32_32x32x16_bf16 v[84:99], v[128:131], v[120:123], 0
    v_mfma_f32_32x32x16_bf16 v[52:67], v[132:135], v[116:119], 0
    s_waitcnt lgkmcnt(0)
    v_mfma_f32_32x32x16_bf16 v[100:115], v[132:135], v[120:123], 0
    s_barrier
    v_mfma_f32_32x32x16_bf16 v[20:35], v[144:147], v[136:139], v[20:35]
    ds_read_b128 v[124:127], v17 offset:12288
    ds_read_b128 v[116:119], v16 offset:8192
    v_mfma_f32_32x32x16_bf16 v[68:83], v[144:147], v[140:143], v[68:83]
    ds_read_b128 v[120:123], v16 offset:9216
    ds_read_b128 v[128:131], v17 offset:13312
    v_mfma_f32_32x32x16_bf16 v[36:51], v[148:151], v[136:139], v[36:51]
    ds_read_b128 v[132:135], v17 offset:14336
    v_mfma_f32_32x32x16_bf16 v[84:99], v[148:151], v[140:143], v[84:99]
    v_mfma_f32_32x32x16_bf16 v[52:67], v[152:155], v[136:139], v[52:67]
    s_waitcnt lgkmcnt(0)
    v_mfma_f32_32x32x16_bf16 v[100:115], v[152:155], v[140:143], v[100:115]
    v_mfma_f32_32x32x16_bf16 v[20:35], v[124:127], v[116:119], v[20:35]
    ds_read_b128 v[144:147], v17 offset:18432
    ds_read_b128 v[136:139], v16 offset:12288
    v_mfma_f32_32x32x16_bf16 v[68:83], v[124:127], v[120:123], v[68:83]
    ds_read_b128 v[140:143], v16 offset:13312
    ds_read_b128 v[148:151], v17 offset:19456
    v_mfma_f32_32x32x16_bf16 v[36:51], v[128:131], v[116:119], v[36:51]
    ds_read_b128 v[152:155], v17 offset:20480
    v_mfma_f32_32x32x16_bf16 v[84:99], v[128:131], v[120:123], v[84:99]
    v_mfma_f32_32x32x16_bf16 v[52:67], v[132:135], v[116:119], v[52:67]
    s_waitcnt lgkmcnt(0)
    v_mfma_f32_32x32x16_bf16 v[100:115], v[132:135], v[120:123], v[100:115]
    s_barrier
    v_mfma_f32_32x32x16_bf16 v[20:35], v[144:147], v[136:139], v[20:35]
    ds_read_b128 v[124:127], v17 offset:24576
    ds_read_b128 v[116:119], v16 offset:16384
    v_mfma_f32_32x32x16_bf16 v[68:83], v[144:147], v[140:143], v[68:83]
    ds_read_b128 v[120:123], v16 offset:17408
    ds_read_b128 v[128:131], v17 offset:25600
    v_mfma_f32_32x32x16_bf16 v[36:51], v[148:151], v[136:139], v[36:51]
    ds_read_b128 v[132:135], v17 offset:26624
    v_mfma_f32_32x32x16_bf16 v[84:99], v[148:151], v[140:143], v[84:99]
    v_mfma_f32_32x32x16_bf16 v[52:67], v[152:155], v[136:139], v[52:67]
    s_waitcnt lgkmcnt(0)
    v_mfma_f32_32x32x16_bf16 v[100:115], v[152:155], v[140:143], v[100:115]
    v_mfma_f32_32x32x16_bf16 v[20:35], v[124:127], v[116:119], v[20:35]
    ds_read_b128 v[144:147], v17 offset:30720
    ds_read_b128 v[136:139], v16 offset:20480
    v_mfma_f32_32x32x16_bf16 v[68:83], v[124:127], v[120:123], v[68:83]
    ds_read_b128 v[140:143], v16 offset:21504
    ds_read_b128 v[148:151], v17 offset:31744
    v_mfma_f32_32x32x16_bf16 v[36:51], v[128:131], v[116:119], v[36:51]
    ds_read_b128 v[152:155], v17 offset:32768
    v_mfma_f32_32x32x16_bf16 v[84:99], v[128:131], v[120:123], v[84:99]
    v_mfma_f32_32x32x16_bf16 v[52:67], v[132:135], v[116:119], v[52:67]
    s_waitcnt lgkmcnt(0)
    v_mfma_f32_32x32x16_bf16 v[100:115], v[132:135], v[120:123], v[100:115]
    v_mfma_f32_32x32x16_bf16 v[20:35], v[144:147], v[136:139], v[20:35]
    ds_read_b128 v[124:127], v17 offset:36864
    ds_read_b128 v[116:119], v16 offset:24576
    v_mfma_f32_32x32x16_bf16 v[68:83], v[144:147], v[140:143], v[68:83]
    ds_read_b128 v[120:123], v16 offset:25600
    ds_read_b128 v[128:131], v17 offset:37888
    v_mfma_f32_32x32x16_bf16 v[36:51], v[148:151], v[136:139], v[36:51]
    ds_read_b128 v[132:135], v17 offset:38912
    v_mfma_f32_32x32x16_bf16 v[84:99], v[148:151], v[140:143], v[84:99]
    v_mfma_f32_32x32x16_bf16 v[52:67], v[152:155], v[136:139], v[52:67]
    s_waitcnt lgkmcnt(0)
    v_mfma_f32_32x32x16_bf16 v[100:115], v[152:155], v[140:143], v[100:115]
    v_mfma_f32_32x32x16_bf16 v[20:35], v[124:127], v[116:119], v[20:35]
    ds_read_b128 v[144:147], v17 offset:43008
    ds_read_b128 v[136:139], v16 offset:28672
    v_mfma_f32_32x32x16_bf16 v[68:83], v[124:127], v[120:123], v[68:83]
    ds_read_b128 v[140:143], v16 offset:29696
    ds_read_b128 v[148:151], v17 offset:44032
    v_mfma_f32_32x32x16_bf16 v[36:51], v[128:131], v[116:119], v[36:51]
    ds_read_b128 v[152:155], v17 offset:45056
    v_mfma_f32_32x32x16_bf16 v[84:99], v[128:131], v[120:123], v[84:99]
    v_mfma_f32_32x32x16_bf16 v[52:67], v[132:135], v[116:119], v[52:67]
    s_waitcnt lgkmcnt(0)
    v_mfma_f32_32x32x16_bf16 v[100:115], v[132:135], v[120:123], v[100:115]
    s_barrier
    v_mfma_f32_32x32x16_bf16 v[20:35], v[144:147], v[136:139], v[20:35]
    ds_read_b128 v[124:127], v18 offset:0
    ds_read_b128 v[116:119], v16 offset:32768
    v_mfma_f32_32x32x16_bf16 v[68:83], v[144:147], v[140:143], v[68:83]
    ds_read_b128 v[120:123], v16 offset:33792
    ds_read_b128 v[128:131], v18 offset:1024
    v_mfma_f32_32x32x16_bf16 v[36:51], v[148:151], v[136:139], v[36:51]
    ds_read_b128 v[132:135], v18 offset:2048
    v_mfma_f32_32x32x16_bf16 v[84:99], v[148:151], v[140:143], v[84:99]
    v_mfma_f32_32x32x16_bf16 v[52:67], v[152:155], v[136:139], v[52:67]
    s_waitcnt lgkmcnt(0)
    v_mfma_f32_32x32x16_bf16 v[100:115], v[152:155], v[140:143], v[100:115]
    v_mfma_f32_32x32x16_bf16 v[20:35], v[124:127], v[116:119], v[20:35]
    ds_read_b128 v[144:147], v18 offset:6144
    ds_read_b128 v[136:139], v16 offset:36864
    v_mfma_f32_32x32x16_bf16 v[68:83], v[124:127], v[120:123], v[68:83]
    ds_read_b128 v[140:143], v16 offset:37888
    ds_read_b128 v[148:151], v18 offset:7168
    v_mfma_f32_32x32x16_bf16 v[36:51], v[128:131], v[116:119], v[36:51]
    ds_read_b128 v[152:155], v18 offset:8192
    v_mfma_f32_32x32x16_bf16 v[84:99], v[128:131], v[120:123], v[84:99]
    v_mfma_f32_32x32x16_bf16 v[52:67], v[132:135], v[116:119], v[52:67]
    s_waitcnt lgkmcnt(0)
    v_mfma_f32_32x32x16_bf16 v[100:115], v[132:135], v[120:123], v[100:115]
    v_mfma_f32_32x32x16_bf16 v[20:35], v[144:147], v[136:139], v[20:35]
    ds_read_b128 v[124:127], v18 offset:12288
    ds_read_b128 v[116:119], v16 offset:40960
    v_mfma_f32_32x32x16_bf16 v[68:83], v[144:147], v[140:143], v[68:83]
    ds_read_b128 v[120:123], v16 offset:41984
    ds_read_b128 v[128:131], v18 offset:13312
    v_mfma_f32_32x32x16_bf16 v[36:51], v[148:151], v[136:139], v[36:51]
    ds_read_b128 v[132:135], v18 offset:14336
    v_mfma_f32_32x32x16_bf16 v[84:99], v[148:151], v[140:143], v[84:99]
    v_mfma_f32_32x32x16_bf16 v[52:67], v[152:155], v[136:139], v[52:67]
    s_waitcnt lgkmcnt(0)
    v_mfma_f32_32x32x16_bf16 v[100:115], v[152:155], v[140:143], v[100:115]
    v_mfma_f32_32x32x16_bf16 v[20:35], v[124:127], v[116:119], v[20:35]
    ds_read_b128 v[144:147], v18 offset:18432
    ds_read_b128 v[136:139], v16 offset:45056
    v_mfma_f32_32x32x16_bf16 v[68:83], v[124:127], v[120:123], v[68:83]
    ds_read_b128 v[140:143], v16 offset:46080
    ds_read_b128 v[148:151], v18 offset:19456
    v_mfma_f32_32x32x16_bf16 v[36:51], v[128:131], v[116:119], v[36:51]
    ds_read_b128 v[152:155], v18 offset:20480
    v_mfma_f32_32x32x16_bf16 v[84:99], v[128:131], v[120:123], v[84:99]
    v_mfma_f32_32x32x16_bf16 v[52:67], v[132:135], v[116:119], v[52:67]
    s_waitcnt lgkmcnt(0)
    v_mfma_f32_32x32x16_bf16 v[100:115], v[132:135], v[120:123], v[100:115]
    s_barrier
    v_mfma_f32_32x32x16_bf16 v[20:35], v[144:147], v[136:139], v[20:35]
    ds_read_b128 v[124:127], v18 offset:24576
    ds_read_b128 v[116:119], v16 offset:0
    v_mfma_f32_32x32x16_bf16 v[68:83], v[144:147], v[140:143], v[68:83]
    ds_read_b128 v[120:123], v16 offset:1024
    ds_read_b128 v[128:131], v18 offset:25600
    v_mfma_f32_32x32x16_bf16 v[36:51], v[148:151], v[136:139], v[36:51]
    ds_read_b128 v[132:135], v18 offset:26624
    v_mfma_f32_32x32x16_bf16 v[84:99], v[148:151], v[140:143], v[84:99]
    v_mfma_f32_32x32x16_bf16 v[52:67], v[152:155], v[136:139], v[52:67]
    s_waitcnt lgkmcnt(0)
    v_mfma_f32_32x32x16_bf16 v[100:115], v[152:155], v[140:143], v[100:115]
    v_mfma_f32_32x32x16_bf16 v[20:35], v[124:127], v[116:119], v[20:35]
    ds_read_b128 v[144:147], v18 offset:30720
    ds_read_b128 v[136:139], v16 offset:4096
    v_mfma_f32_32x32x16_bf16 v[68:83], v[124:127], v[120:123], v[68:83]
    ds_read_b128 v[140:143], v16 offset:5120
    ds_read_b128 v[148:151], v18 offset:31744
    v_mfma_f32_32x32x16_bf16 v[36:51], v[128:131], v[116:119], v[36:51]
    ds_read_b128 v[152:155], v18 offset:32768
    v_mfma_f32_32x32x16_bf16 v[84:99], v[128:131], v[120:123], v[84:99]
    v_mfma_f32_32x32x16_bf16 v[52:67], v[132:135], v[116:119], v[52:67]
    s_waitcnt lgkmcnt(0)
    v_mfma_f32_32x32x16_bf16 v[100:115], v[132:135], v[120:123], v[100:115]
    v_mfma_f32_32x32x16_bf16 v[20:35], v[144:147], v[136:139], v[20:35]
    ds_read_b128 v[124:127], v18 offset:36864
    ds_read_b128 v[116:119], v16 offset:8192
    v_mfma_f32_32x32x16_bf16 v[68:83], v[144:147], v[140:143], v[68:83]
    ds_read_b128 v[120:123], v16 offset:9216
    ds_read_b128 v[128:131], v18 offset:37888
    v_mfma_f32_32x32x16_bf16 v[36:51], v[148:151], v[136:139], v[36:51]
    ds_read_b128 v[132:135], v18 offset:38912
    v_mfma_f32_32x32x16_bf16 v[84:99], v[148:151], v[140:143], v[84:99]
    v_mfma_f32_32x32x16_bf16 v[52:67], v[152:155], v[136:139], v[52:67]
    s_waitcnt lgkmcnt(0)
    v_mfma_f32_32x32x16_bf16 v[100:115], v[152:155], v[140:143], v[100:115]
    v_mfma_f32_32x32x16_bf16 v[20:35], v[124:127], v[116:119], v[20:35]
    ds_read_b128 v[144:147], v18 offset:43008
    ds_read_b128 v[136:139], v16 offset:12288
    v_mfma_f32_32x32x16_bf16 v[68:83], v[124:127], v[120:123], v[68:83]
    ds_read_b128 v[140:143], v16 offset:13312
    ds_read_b128 v[148:151], v18 offset:44032
    v_mfma_f32_32x32x16_bf16 v[36:51], v[128:131], v[116:119], v[36:51]
    ds_read_b128 v[152:155], v18 offset:45056
    v_mfma_f32_32x32x16_bf16 v[84:99], v[128:131], v[120:123], v[84:99]
    v_mfma_f32_32x32x16_bf16 v[52:67], v[132:135], v[116:119], v[52:67]
    s_waitcnt lgkmcnt(0)
    v_mfma_f32_32x32x16_bf16 v[100:115], v[132:135], v[120:123], v[100:115]
    s_barrier
    v_mfma_f32_32x32x16_bf16 v[20:35], v[144:147], v[136:139], v[20:35]
    ds_read_b128 v[124:127], v17 offset:0
    ds_read_b128 v[116:119], v16 offset:16384
    v_mfma_f32_32x32x16_bf16 v[68:83], v[144:147], v[140:143], v[68:83]
    ds_read_b128 v[120:123], v16 offset:17408
    ds_read_b128 v[128:131], v17 offset:1024
    v_mfma_f32_32x32x16_bf16 v[36:51], v[148:151], v[136:139], v[36:51]
    ds_read_b128 v[132:135], v17 offset:2048
    v_mfma_f32_32x32x16_bf16 v[84:99], v[148:151], v[140:143], v[84:99]
    v_mfma_f32_32x32x16_bf16 v[52:67], v[152:155], v[136:139], v[52:67]
    s_waitcnt lgkmcnt(0)
    v_mfma_f32_32x32x16_bf16 v[100:115], v[152:155], v[140:143], v[100:115]
    v_mfma_f32_32x32x16_bf16 v[20:35], v[124:127], v[116:119], v[20:35]
    ds_read_b128 v[144:147], v17 offset:6144
    ds_read_b128 v[136:139], v16 offset:20480
    v_mfma_f32_32x32x16_bf16 v[68:83], v[124:127], v[120:123], v[68:83]
    ds_read_b128 v[140:143], v16 offset:21504
    ds_read_b128 v[148:151], v17 offset:7168
    v_mfma_f32_32x32x16_bf16 v[36:51], v[128:131], v[116:119], v[36:51]
    ds_read_b128 v[152:155], v17 offset:8192
    v_mfma_f32_32x32x16_bf16 v[84:99], v[128:131], v[120:123], v[84:99]
    v_mfma_f32_32x32x16_bf16 v[52:67], v[132:135], v[116:119], v[52:67]
    s_waitcnt lgkmcnt(0)
    v_mfma_f32_32x32x16_bf16 v[100:115], v[132:135], v[120:123], v[100:115]
    v_mfma_f32_32x32x16_bf16 v[20:35], v[144:147], v[136:139], v[20:35]
    ds_read_b128 v[124:127], v17 offset:12288
    ds_read_b128 v[116:119], v16 offset:24576
    v_mfma_f32_32x32x16_bf16 v[68:83], v[144:147], v[140:143], v[68:83]
    ds_read_b128 v[120:123], v16 offset:25600
    ds_read_b128 v[128:131], v17 offset:13312
    v_mfma_f32_32x32x16_bf16 v[36:51], v[148:151], v[136:139], v[36:51]
    ds_read_b128 v[132:135], v17 offset:14336
    v_mfma_f32_32x32x16_bf16 v[84:99], v[148:151], v[140:143], v[84:99]
    v_mfma_f32_32x32x16_bf16 v[52:67], v[152:155], v[136:139], v[52:67]
    s_waitcnt lgkmcnt(0)
    v_mfma_f32_32x32x16_bf16 v[100:115], v[152:155], v[140:143], v[100:115]
    v_mfma_f32_32x32x16_bf16 v[20:35], v[124:127], v[116:119], v[20:35]
    ds_read_b128 v[144:147], v17 offset:18432
    ds_read_b128 v[136:139], v16 offset:28672
    v_mfma_f32_32x32x16_bf16 v[68:83], v[124:127], v[120:123], v[68:83]
    ds_read_b128 v[140:143], v16 offset:29696
    ds_read_b128 v[148:151], v17 offset:19456
    v_mfma_f32_32x32x16_bf16 v[36:51], v[128:131], v[116:119], v[36:51]
    ds_read_b128 v[152:155], v17 offset:20480
    v_mfma_f32_32x32x16_bf16 v[84:99], v[128:131], v[120:123], v[84:99]
    v_mfma_f32_32x32x16_bf16 v[52:67], v[132:135], v[116:119], v[52:67]
    s_waitcnt lgkmcnt(0)
    v_mfma_f32_32x32x16_bf16 v[100:115], v[132:135], v[120:123], v[100:115]
    s_barrier
    v_mfma_f32_32x32x16_bf16 v[20:35], v[144:147], v[136:139], v[20:35]
    ds_read_b128 v[124:127], v17 offset:24576
    ds_read_b128 v[116:119], v16 offset:32768
    v_mfma_f32_32x32x16_bf16 v[68:83], v[144:147], v[140:143], v[68:83]
    ds_read_b128 v[120:123], v16 offset:33792
    ds_read_b128 v[128:131], v17 offset:25600
    v_mfma_f32_32x32x16_bf16 v[36:51], v[148:151], v[136:139], v[36:51]
    ds_read_b128 v[132:135], v17 offset:26624
    v_mfma_f32_32x32x16_bf16 v[84:99], v[148:151], v[140:143], v[84:99]
    v_mfma_f32_32x32x16_bf16 v[52:67], v[152:155], v[136:139], v[52:67]
    s_waitcnt lgkmcnt(0)
    v_mfma_f32_32x32x16_bf16 v[100:115], v[152:155], v[140:143], v[100:115]
    v_mfma_f32_32x32x16_bf16 v[20:35], v[124:127], v[116:119], v[20:35]
    ds_read_b128 v[144:147], v17 offset:30720
    ds_read_b128 v[136:139], v16 offset:36864
    v_mfma_f32_32x32x16_bf16 v[68:83], v[124:127], v[120:123], v[68:83]
    ds_read_b128 v[140:143], v16 offset:37888
    ds_read_b128 v[148:151], v17 offset:31744
    v_mfma_f32_32x32x16_bf16 v[36:51], v[128:131], v[116:119], v[36:51]
    ds_read_b128 v[152:155], v17 offset:32768
    v_mfma_f32_32x32x16_bf16 v[84:99], v[128:131], v[120:123], v[84:99]
    v_mfma_f32_32x32x16_bf16 v[52:67], v[132:135], v[116:119], v[52:67]
    s_waitcnt lgkmcnt(0)
    v_mfma_f32_32x32x16_bf16 v[100:115], v[132:135], v[120:123], v[100:115]
    v_mfma_f32_32x32x16_bf16 v[20:35], v[144:147], v[136:139], v[20:35]
    ds_read_b128 v[124:127], v17 offset:36864
    ds_read_b128 v[116:119], v16 offset:40960
    v_mfma_f32_32x32x16_bf16 v[68:83], v[144:147], v[140:143], v[68:83]
    ds_read_b128 v[120:123], v16 offset:41984
    ds_read_b128 v[128:131], v17 offset:37888
    v_mfma_f32_32x32x16_bf16 v[36:51], v[148:151], v[136:139], v[36:51]
    ds_read_b128 v[132:135], v17 offset:38912
    v_mfma_f32_32x32x16_bf16 v[84:99], v[148:151], v[140:143], v[84:99]
    v_mfma_f32_32x32x16_bf16 v[52:67], v[152:155], v[136:139], v[52:67]
    s_waitcnt lgkmcnt(0)
    v_mfma_f32_32x32x16_bf16 v[100:115], v[152:155], v[140:143], v[100:115]
    v_mfma_f32_32x32x16_bf16 v[20:35], v[124:127], v[116:119], v[20:35]
    ds_read_b128 v[144:147], v17 offset:43008
    ds_read_b128 v[136:139], v16 offset:45056
    v_mfma_f32_32x32x16_bf16 v[68:83], v[124:127], v[120:123], v[68:83]
    ds_read_b128 v[140:143], v16 offset:46080
    ds_read_b128 v[148:151], v17 offset:44032
    v_mfma_f32_32x32x16_bf16 v[36:51], v[128:131], v[116:119], v[36:51]
    ds_read_b128 v[152:155], v17 offset:45056
    v_mfma_f32_32x32x16_bf16 v[84:99], v[128:131], v[120:123], v[84:99]
    v_mfma_f32_32x32x16_bf16 v[52:67], v[132:135], v[116:119], v[52:67]
    s_waitcnt lgkmcnt(0)
    v_mfma_f32_32x32x16_bf16 v[100:115], v[132:135], v[120:123], v[100:115]
    s_barrier
    v_mfma_f32_32x32x16_bf16 v[20:35], v[144:147], v[136:139], v[20:35]
    ds_read_b128 v[124:127], v18 offset:0
    ds_read_b128 v[116:119], v16 offset:0
    v_mfma_f32_32x32x16_bf16 v[68:83], v[144:147], v[140:143], v[68:83]
    ds_read_b128 v[120:123], v16 offset:1024
    ds_read_b128 v[128:131], v18 offset:1024
    v_mfma_f32_32x32x16_bf16 v[36:51], v[148:151], v[136:139], v[36:51]
    ds_read_b128 v[132:135], v18 offset:2048
    v_mfma_f32_32x32x16_bf16 v[84:99], v[148:151], v[140:143], v[84:99]
    v_mfma_f32_32x32x16_bf16 v[52:67], v[152:155], v[136:139], v[52:67]
    s_waitcnt lgkmcnt(0)
    v_mfma_f32_32x32x16_bf16 v[100:115], v[152:155], v[140:143], v[100:115]
    v_mfma_f32_32x32x16_bf16 v[20:35], v[124:127], v[116:119], v[20:35]
    ds_read_b128 v[144:147], v18 offset:6144
    ds_read_b128 v[136:139], v16 offset:4096
    v_mfma_f32_32x32x16_bf16 v[68:83], v[124:127], v[120:123], v[68:83]
    ds_read_b128 v[140:143], v16 offset:5120
    ds_read_b128 v[148:151], v18 offset:7168
    v_mfma_f32_32x32x16_bf16 v[36:51], v[128:131], v[116:119], v[36:51]
    ds_read_b128 v[152:155], v18 offset:8192
    v_mfma_f32_32x32x16_bf16 v[84:99], v[128:131], v[120:123], v[84:99]
    v_mfma_f32_32x32x16_bf16 v[52:67], v[132:135], v[116:119], v[52:67]
    s_waitcnt lgkmcnt(0)
    v_mfma_f32_32x32x16_bf16 v[100:115], v[132:135], v[120:123], v[100:115]
    v_mfma_f32_32x32x16_bf16 v[20:35], v[144:147], v[136:139], v[20:35]
    ds_read_b128 v[124:127], v18 offset:12288
    ds_read_b128 v[116:119], v16 offset:8192
    v_mfma_f32_32x32x16_bf16 v[68:83], v[144:147], v[140:143], v[68:83]
    ds_read_b128 v[120:123], v16 offset:9216
    ds_read_b128 v[128:131], v18 offset:13312
    v_mfma_f32_32x32x16_bf16 v[36:51], v[148:151], v[136:139], v[36:51]
    ds_read_b128 v[132:135], v18 offset:14336
    v_mfma_f32_32x32x16_bf16 v[84:99], v[148:151], v[140:143], v[84:99]
    v_mfma_f32_32x32x16_bf16 v[52:67], v[152:155], v[136:139], v[52:67]
    s_waitcnt lgkmcnt(0)
    v_mfma_f32_32x32x16_bf16 v[100:115], v[152:155], v[140:143], v[100:115]
    v_mfma_f32_32x32x16_bf16 v[20:35], v[124:127], v[116:119], v[20:35]
    ds_read_b128 v[144:147], v18 offset:18432
    ds_read_b128 v[136:139], v16 offset:12288
    v_mfma_f32_32x32x16_bf16 v[68:83], v[124:127], v[120:123], v[68:83]
    ds_read_b128 v[140:143], v16 offset:13312
    ds_read_b128 v[148:151], v18 offset:19456
    v_mfma_f32_32x32x16_bf16 v[36:51], v[128:131], v[116:119], v[36:51]
    ds_read_b128 v[152:155], v18 offset:20480
    v_mfma_f32_32x32x16_bf16 v[84:99], v[128:131], v[120:123], v[84:99]
    v_mfma_f32_32x32x16_bf16 v[52:67], v[132:135], v[116:119], v[52:67]
    s_waitcnt lgkmcnt(0)
    v_mfma_f32_32x32x16_bf16 v[100:115], v[132:135], v[120:123], v[100:115]
    s_barrier
    v_mfma_f32_32x32x16_bf16 v[20:35], v[144:147], v[136:139], v[20:35]
    ds_read_b128 v[124:127], v18 offset:24576
    ds_read_b128 v[116:119], v16 offset:16384
    v_mfma_f32_32x32x16_bf16 v[68:83], v[144:147], v[140:143], v[68:83]
    ds_read_b128 v[120:123], v16 offset:17408
    ds_read_b128 v[128:131], v18 offset:25600
    v_mfma_f32_32x32x16_bf16 v[36:51], v[148:151], v[136:139], v[36:51]
    ds_read_b128 v[132:135], v18 offset:26624
    v_mfma_f32_32x32x16_bf16 v[84:99], v[148:151], v[140:143], v[84:99]
    v_mfma_f32_32x32x16_bf16 v[52:67], v[152:155], v[136:139], v[52:67]
    s_waitcnt lgkmcnt(0)
    v_mfma_f32_32x32x16_bf16 v[100:115], v[152:155], v[140:143], v[100:115]
    v_mfma_f32_32x32x16_bf16 v[20:35], v[124:127], v[116:119], v[20:35]
    ds_read_b128 v[144:147], v18 offset:30720
    ds_read_b128 v[136:139], v16 offset:20480
    v_mfma_f32_32x32x16_bf16 v[68:83], v[124:127], v[120:123], v[68:83]
    ds_read_b128 v[140:143], v16 offset:21504
    ds_read_b128 v[148:151], v18 offset:31744
    v_mfma_f32_32x32x16_bf16 v[36:51], v[128:131], v[116:119], v[36:51]
    ds_read_b128 v[152:155], v18 offset:32768
    v_mfma_f32_32x32x16_bf16 v[84:99], v[128:131], v[120:123], v[84:99]
    v_mfma_f32_32x32x16_bf16 v[52:67], v[132:135], v[116:119], v[52:67]
    s_waitcnt lgkmcnt(0)
    v_mfma_f32_32x32x16_bf16 v[100:115], v[132:135], v[120:123], v[100:115]
    v_mfma_f32_32x32x16_bf16 v[20:35], v[144:147], v[136:139], v[20:35]
    ds_read_b128 v[124:127], v18 offset:36864
    ds_read_b128 v[116:119], v16 offset:24576
    v_mfma_f32_32x32x16_bf16 v[68:83], v[144:147], v[140:143], v[68:83]
    ds_read_b128 v[120:123], v16 offset:25600
    ds_read_b128 v[128:131], v18 offset:37888
    v_mfma_f32_32x32x16_bf16 v[36:51], v[148:151], v[136:139], v[36:51]
    ds_read_b128 v[132:135], v18 offset:38912
    ds_read_b128 v[156:159], v1 offset:0
    v_mfma_f32_32x32x16_bf16 v[84:99], v[148:151], v[140:143], v[84:99]
    ds_read_b128 v[160:163], v1 offset:512
    v_mfma_f32_32x32x16_bf16 v[52:67], v[152:155], v[136:139], v[52:67]
    s_waitcnt lgkmcnt(0)
    v_mfma_f32_32x32x16_bf16 v[100:115], v[152:155], v[140:143], v[100:115]
    v_mfma_f32_32x32x16_bf16 v[20:35], v[124:127], v[116:119], v[20:35]
    ds_read_b128 v[144:147], v18 offset:43008
    ds_read_b128 v[136:139], v16 offset:28672
    v_mfma_f32_32x32x16_bf16 v[68:83], v[124:127], v[120:123], v[68:83]
    ds_read_b128 v[140:143], v16 offset:29696
    ds_read_b128 v[148:151], v18 offset:44032
    v_mfma_f32_32x32x16_bf16 v[36:51], v[128:131], v[116:119], v[36:51]
    ds_read_b128 v[152:155], v18 offset:45056
    v_mfma_f32_32x32x16_bf16 v[84:99], v[128:131], v[120:123], v[84:99]
    v_mfma_f32_32x32x16_bf16 v[52:67], v[132:135], v[116:119], v[52:67]
    s_waitcnt lgkmcnt(0)
    v_mfma_f32_32x32x16_bf16 v[100:115], v[132:135], v[120:123], v[100:115]
    v_mfma_f32_32x32x16_bf16 v[20:35], v[144:147], v[136:139], v[20:35]
    ds_read_b32 v124, v2 offset:0
    ds_read_b32 v128, v2 offset:128
    ds_read_b32 v132, v2 offset:256
    v_mfma_f32_32x32x16_bf16 v[68:83], v[144:147], v[140:143], v[68:83]
    v_mov_b32 v117, 0
    v_mov_b32 v118, 0
    v_mov_b32 v119, 0
    v_mov_b32 v121, 0
    v_mfma_f32_32x32x16_bf16 v[36:51], v[148:151], v[136:139], v[36:51]
    v_mov_b32 v122, 0
    v_mov_b32 v123, 0
    v_mov_b32 v125, 0
    v_mov_b32 v126, 0
    v_mfma_f32_32x32x16_bf16 v[84:99], v[148:151], v[140:143], v[84:99]
    v_mov_b32 v127, 0
    v_mov_b32 v129, 0
    v_mov_b32 v130, 0
    v_mov_b32 v131, 0
    v_mfma_f32_32x32x16_bf16 v[52:67], v[152:155], v[136:139], v[52:67]
    v_mov_b32 v133, 0
    v_mov_b32 v134, 0
    v_mov_b32 v135, 0
    v_cndmask_b32 v116, 0, v156, vcc
    v_mfma_f32_32x32x16_bf16 v[100:115], v[152:155], v[140:143], v[100:115]
    v_cndmask_b32 v120, 0, v160, vcc
    s_waitcnt lgkmcnt(0)
    s_branch sequential_preLN__softmax_full_mha__geglu_ffn__prompt_kernel_pg_gelu
.p2align 12
sequential_preLN__softmax_full_mha__geglu_ffn__prompt_kernel_pad_gelu:
    s_branch sequential_preLN__softmax_full_mha__geglu_ffn__prompt_kernel_ret_gelu
sequential_preLN__softmax_full_mha__geglu_ffn__prompt_kernel_pg_gelu:
    v_mfma_f32_32x32x16_bf16 v[20:35], v[124:127], v[116:119], v[20:35]
    s_cmp_lt_u32 s42, 86
    s_cselect_b32 s28, s45, 0x7fff0000
    s_add_u32 s42, s42, 1
    s_add_u32 s45, s45, 2048
    s_nop 7
    v_pk_mul_f32 v[136:137], v[20:21], v[20:21]
    v_pk_mul_f32 v[138:139], v[22:23], v[22:23]
    v_pk_mul_f32 v[140:141], v[24:25], v[24:25]
    v_pk_mul_f32 v[142:143], v[26:27], v[26:27]
    v_pk_fma_f32 v[136:137], v[136:137], v[158:159], v[156:157] op_sel:[0,0,1] op_sel_hi:[1,0,1]
    v_pk_fma_f32 v[138:139], v[138:139], v[158:159], v[156:157] op_sel:[0,0,1] op_sel_hi:[1,0,1]
    v_pk_fma_f32 v[140:141], v[140:141], v[158:159], v[156:157] op_sel:[0,0,1] op_sel_hi:[1,0,1]
    v_pk_fma_f32 v[142:143], v[142:143], v[158:159], v[156:157] op_sel:[0,0,1] op_sel_hi:[1,0,1]
    v_pk_mul_f32 v[136:137], v[136:137], v[20:21]
    v_pk_mul_f32 v[138:139], v[138:139], v[22:23]
    v_pk_mul_f32 v[140:141], v[140:141], v[24:25]
    v_pk_mul_f32 v[142:143], v[142:143], v[26:27]
    v_mfma_f32_32x32x16_bf16 v[68:83], v[124:127], v[120:123], v[68:83]
    v_exp_f32 v136, v136
    v_exp_f32 v137, v137
    v_exp_f32 v138, v138
    v_exp_f32 v139, v139
    v_exp_f32 v140, v140
    v_exp_f32 v141, v141
    v_exp_f32 v142, v142
    v_exp_f32 v143, v143
    v_pk_mul_f32 v[20:21], v[20:21], v[28:29]
    v_pk_mul_f32 v[22:23], v[22:23], v[30:31]
    v_pk_mul_f32 v[24:25], v[24:25], v[32:33]
    v_pk_mul_f32 v[26:27], v[26:27], v[34:35]
    v_pk_fma_f32 v[136:137], v[136:137], v[158:159], v[158:159] op_sel:[0,1,1]
    v_pk_fma_f32 v[138:139], v[138:139], v[158:159], v[158:159] op_sel:[0,1,1]
    v_pk_fma_f32 v[140:141], v[140:141], v[158:159], v[158:159] op_sel:[0,1,1]
    v_pk_fma_f32 v[142:143], v[142:143], v[158:159], v[158:159] op_sel:[0,1,1]
    v_rcp_f32 v136, v136
    v_rcp_f32 v137, v137
    v_rcp_f32 v138, v138
    v_rcp_f32 v139, v139
    v_rcp_f32 v140, v140
    v_rcp_f32 v141, v141
    v_rcp_f32 v142, v142
    v_rcp_f32 v143, v143
    v_pk_mul_f32 v[20:21], v[20:21], v[136:137]
    v_pk_mul_f32 v[22:23], v[22:23], v[138:139]
    v_pk_mul_f32 v[24:25], v[24:25], v[140:141]
    v_pk_mul_f32 v[26:27], v[26:27], v[142:143]
    v_cvt_pk_bf16_f32 v20, v20, v21
    v_cvt_pk_bf16_f32 v21, v22, v23
    v_cvt_pk_bf16_f32 v22, v24, v25
    v_cvt_pk_bf16_f32 v23, v26, v27
    buffer_store_dwordx4 v[20:23], v3, s[20:23], s28 offen offset:0 sc1
    v_pk_mul_f32 v[136:137], v[68:69], v[68:69]
    v_pk_mul_f32 v[138:139], v[70:71], v[70:71]
    v_pk_mul_f32 v[140:141], v[72:73], v[72:73]
    v_pk_mul_f32 v[142:143], v[74:75], v[74:75]
    v_pk_fma_f32 v[136:137], v[136:137], v[162:163], v[160:161] op_sel:[0,0,1] op_sel_hi:[1,0,1]
    v_pk_fma_f32 v[138:139], v[138:139], v[162:163], v[160:161] op_sel:[0,0,1] op_sel_hi:[1,0,1]
    v_pk_fma_f32 v[140:141], v[140:141], v[162:163], v[160:161] op_sel:[0,0,1] op_sel_hi:[1,0,1]
    v_pk_fma_f32 v[142:143], v[142:143], v[162:163], v[160:161] op_sel:[0,0,1] op_sel_hi:[1,0,1]
    v_pk_mul_f32 v[136:137], v[136:137], v[68:69]
    v_pk_mul_f32 v[138:139], v[138:139], v[70:71]
    v_pk_mul_f32 v[140:141], v[140:141], v[72:73]
    v_pk_mul_f32 v[142:143], v[142:143], v[74:75]
    v_mfma_f32_32x32x16_bf16 v[36:51], v[128:131], v[116:119], v[36:51]
    v_exp_f32 v136, v136
    v_exp_f32 v137, v137
    v_exp_f32 v138, v138
    v_exp_f32 v139, v139
    v_exp_f32 v140, v140
    v_exp_f32 v141, v141
    v_exp_f32 v142, v142
    v_exp_f32 v143, v143
    v_pk_mul_f32 v[68:69], v[68:69], v[76:77]
    v_pk_mul_f32 v[70:71], v[70:71], v[78:79]
    v_pk_mul_f32 v[72:73], v[72:73], v[80:81]
    v_pk_mul_f32 v[74:75], v[74:75], v[82:83]
    v_pk_fma_f32 v[136:137], v[136:137], v[162:163], v[162:163] op_sel:[0,1,1]
    v_pk_fma_f32 v[138:139], v[138:139], v[162:163], v[162:163] op_sel:[0,1,1]
    v_pk_fma_f32 v[140:141], v[140:141], v[162:163], v[162:163] op_sel:[0,1,1]
    v_pk_fma_f32 v[142:143], v[142:143], v[162:163], v[162:163] op_sel:[0,1,1]
    v_rcp_f32 v136, v136
    v_rcp_f32 v137, v137
    v_rcp_f32 v138, v138
    v_rcp_f32 v139, v139
    v_rcp_f32 v140, v140
    v_rcp_f32 v141, v141
    v_rcp_f32 v142, v142
    v_rcp_f32 v143, v143
    v_pk_mul_f32 v[68:69], v[68:69], v[136:137]
    v_pk_mul_f32 v[70:71], v[70:71], v[138:139]
    v_pk_mul_f32 v[72:73], v[72:73], v[140:141]
    v_pk_mul_f32 v[74:75], v[74:75], v[142:143]
    v_cvt_pk_bf16_f32 v68, v68, v69
    v_cvt_pk_bf16_f32 v69, v70, v71
    v_cvt_pk_bf16_f32 v70, v72, v73
    v_cvt_pk_bf16_f32 v71, v74, v75
    buffer_store_dwordx4 v[68:71], v3, s[20:23], s28 offen offset:1024 sc1
    s_cmp_lt_u32 s42, 86
    s_cselect_b32 s28, s45, 0x7fff0000
    s_add_u32 s42, s42, 1
    s_add_u32 s45, s45, 2048
    v_pk_mul_f32 v[136:137], v[36:37], v[36:37]
    v_pk_mul_f32 v[138:139], v[38:39], v[38:39]
    v_pk_mul_f32 v[140:141], v[40:41], v[40:41]
    v_pk_mul_f32 v[142:143], v[42:43], v[42:43]
    v_pk_fma_f32 v[136:137], v[136:137], v[158:159], v[156:157] op_sel:[0,0,1] op_sel_hi:[1,0,1]
    v_pk_fma_f32 v[138:139], v[138:139], v[158:159], v[156:157] op_sel:[0,0,1] op_sel_hi:[1,0,1]
    v_pk_fma_f32 v[140:141], v[140:141], v[158:159], v[156:157] op_sel:[0,0,1] op_sel_hi:[1,0,1]
    v_pk_fma_f32 v[142:143], v[142:143], v[158:159], v[156:157] op_sel:[0,0,1] op_sel_hi:[1,0,1]
    v_pk_mul_f32 v[136:137], v[136:137], v[36:37]
    v_pk_mul_f32 v[138:139], v[138:139], v[38:39]
    v_pk_mul_f32 v[140:141], v[140:141], v[40:41]
    v_pk_mul_f32 v[142:143], v[142:143], v[42:43]
    v_mfma_f32_32x32x16_bf16 v[84:99], v[128:131], v[120:123], v[84:99]
    v_exp_f32 v136, v136
    v_exp_f32 v137, v137
    v_exp_f32 v138, v138
    v_exp_f32 v139, v139
    v_exp_f32 v140, v140
    v_exp_f32 v141, v141
    v_exp_f32 v142, v142
    v_exp_f32 v143, v143
    v_pk_mul_f32 v[36:37], v[36:37], v[44:45]
    v_pk_mul_f32 v[38:39], v[38:39], v[46:47]
    v_pk_mul_f32 v[40:41], v[40:41], v[48:49]
    v_pk_mul_f32 v[42:43], v[42:43], v[50:51]
    v_pk_fma_f32 v[136:137], v[136:137], v[158:159], v[158:159] op_sel:[0,1,1]
    v_pk_fma_f32 v[138:139], v[138:139], v[158:159], v[158:159] op_sel:[0,1,1]
    v_pk_fma_f32 v[140:141], v[140:141], v[158:159], v[158:159] op_sel:[0,1,1]
    v_pk_fma_f32 v[142:143], v[142:143], v[158:159], v[158:159] op_sel:[0,1,1]
    v_rcp_f32 v136, v136
    v_rcp_f32 v137, v137
    v_rcp_f32 v138, v138
    v_rcp_f32 v139, v139
    v_rcp_f32 v140, v140
    v_rcp_f32 v141, v141
    v_rcp_f32 v142, v142
    v_rcp_f32 v143, v143
    v_pk_mul_f32 v[36:37], v[36:37], v[136:137]
    v_pk_mul_f32 v[38:39], v[38:39], v[138:139]
    v_pk_mul_f32 v[40:41], v[40:41], v[140:141]
    v_pk_mul_f32 v[42:43], v[42:43], v[142:143]
    v_cvt_pk_bf16_f32 v36, v36, v37
    v_cvt_pk_bf16_f32 v37, v38, v39
    v_cvt_pk_bf16_f32 v38, v40, v41
    v_cvt_pk_bf16_f32 v39, v42, v43
    buffer_store_dwordx4 v[36:39], v3, s[20:23], s28 offen offset:0 sc1
    v_pk_mul_f32 v[136:137], v[84:85], v[84:85]
    v_pk_mul_f32 v[138:139], v[86:87], v[86:87]
    v_pk_mul_f32 v[140:141], v[88:89], v[88:89]
    v_pk_mul_f32 v[142:143], v[90:91], v[90:91]
    v_pk_fma_f32 v[136:137], v[136:137], v[162:163], v[160:161] op_sel:[0,0,1] op_sel_hi:[1,0,1]
    v_pk_fma_f32 v[138:139], v[138:139], v[162:163], v[160:161] op_sel:[0,0,1] op_sel_hi:[1,0,1]
    v_pk_fma_f32 v[140:141], v[140:141], v[162:163], v[160:161] op_sel:[0,0,1] op_sel_hi:[1,0,1]
    v_pk_fma_f32 v[142:143], v[142:143], v[162:163], v[160:161] op_sel:[0,0,1] op_sel_hi:[1,0,1]
    v_pk_mul_f32 v[136:137], v[136:137], v[84:85]
    v_pk_mul_f32 v[138:139], v[138:139], v[86:87]
    v_pk_mul_f32 v[140:141], v[140:141], v[88:89]
    v_pk_mul_f32 v[142:143], v[142:143], v[90:91]
    v_mfma_f32_32x32x16_bf16 v[52:67], v[132:135], v[116:119], v[52:67]
    v_exp_f32 v136, v136
    v_exp_f32 v137, v137
    v_exp_f32 v138, v138
    v_exp_f32 v139, v139
    v_exp_f32 v140, v140
    v_exp_f32 v141, v141
    v_exp_f32 v142, v142
    v_exp_f32 v143, v143
    v_pk_mul_f32 v[84:85], v[84:85], v[92:93]
    v_pk_mul_f32 v[86:87], v[86:87], v[94:95]
    v_pk_mul_f32 v[88:89], v[88:89], v[96:97]
    v_pk_mul_f32 v[90:91], v[90:91], v[98:99]
    v_pk_fma_f32 v[136:137], v[136:137], v[162:163], v[162:163] op_sel:[0,1,1]
    v_pk_fma_f32 v[138:139], v[138:139], v[162:163], v[162:163] op_sel:[0,1,1]
    v_pk_fma_f32 v[140:141], v[140:141], v[162:163], v[162:163] op_sel:[0,1,1]
    v_pk_fma_f32 v[142:143], v[142:143], v[162:163], v[162:163] op_sel:[0,1,1]
    v_rcp_f32 v136, v136
    v_rcp_f32 v137, v137
    v_rcp_f32 v138, v138
    v_rcp_f32 v139, v139
    v_rcp_f32 v140, v140
    v_rcp_f32 v141, v141
    v_rcp_f32 v142, v142
    v_rcp_f32 v143, v143
    v_pk_mul_f32 v[84:85], v[84:85], v[136:137]
    v_pk_mul_f32 v[86:87], v[86:87], v[138:139]
    v_pk_mul_f32 v[88:89], v[88:89], v[140:141]
    v_pk_mul_f32 v[90:91], v[90:91], v[142:143]
    v_cvt_pk_bf16_f32 v84, v84, v85
    v_cvt_pk_bf16_f32 v85, v86, v87
    v_cvt_pk_bf16_f32 v86, v88, v89
    v_cvt_pk_bf16_f32 v87, v90, v91
    buffer_store_dwordx4 v[84:87], v3, s[20:23], s28 offen offset:1024 sc1
    s_cmp_lt_u32 s42, 86
    s_cselect_b32 s28, s45, 0x7fff0000
    s_add_u32 s42, s42, 1
    s_add_u32 s45, s45, 2048
    v_pk_mul_f32 v[136:137], v[52:53], v[52:53]
    v_pk_mul_f32 v[138:139], v[54:55], v[54:55]
    v_pk_mul_f32 v[140:141], v[56:57], v[56:57]
    v_pk_mul_f32 v[142:143], v[58:59], v[58:59]
    v_pk_fma_f32 v[136:137], v[136:137], v[158:159], v[156:157] op_sel:[0,0,1] op_sel_hi:[1,0,1]
    v_pk_fma_f32 v[138:139], v[138:139], v[158:159], v[156:157] op_sel:[0,0,1] op_sel_hi:[1,0,1]
    v_pk_fma_f32 v[140:141], v[140:141], v[158:159], v[156:157] op_sel:[0,0,1] op_sel_hi:[1,0,1]
    v_pk_fma_f32 v[142:143], v[142:143], v[158:159], v[156:157] op_sel:[0,0,1] op_sel_hi:[1,0,1]
    v_pk_mul_f32 v[136:137], v[136:137], v[52:53]
    v_pk_mul_f32 v[138:139], v[138:139], v[54:55]
    v_pk_mul_f32 v[140:141], v[140:141], v[56:57]
    v_pk_mul_f32 v[142:143], v[142:143], v[58:59]
    v_mfma_f32_32x32x16_bf16 v[100:115], v[132:135], v[120:123], v[100:115]
    v_exp_f32 v136, v136
    v_exp_f32 v137, v137
    v_exp_f32 v138, v138
    v_exp_f32 v139, v139
    v_exp_f32 v140, v140
    v_exp_f32 v141, v141
    v_exp_f32 v142, v142
    v_exp_f32 v143, v143
    v_pk_mul_f32 v[52:53], v[52:53], v[60:61]
    v_pk_mul_f32 v[54:55], v[54:55], v[62:63]
    v_pk_mul_f32 v[56:57], v[56:57], v[64:65]
    v_pk_mul_f32 v[58:59], v[58:59], v[66:67]
    v_pk_fma_f32 v[136:137], v[136:137], v[158:159], v[158:159] op_sel:[0,1,1]
    v_pk_fma_f32 v[138:139], v[138:139], v[158:159], v[158:159] op_sel:[0,1,1]
    v_pk_fma_f32 v[140:141], v[140:141], v[158:159], v[158:159] op_sel:[0,1,1]
    v_pk_fma_f32 v[142:143], v[142:143], v[158:159], v[158:159] op_sel:[0,1,1]
    v_rcp_f32 v136, v136
    v_rcp_f32 v137, v137
    v_rcp_f32 v138, v138
    v_rcp_f32 v139, v139
    v_rcp_f32 v140, v140
    v_rcp_f32 v141, v141
    v_rcp_f32 v142, v142
    v_rcp_f32 v143, v143
    v_pk_mul_f32 v[52:53], v[52:53], v[136:137]
    v_pk_mul_f32 v[54:55], v[54:55], v[138:139]
    v_pk_mul_f32 v[56:57], v[56:57], v[140:141]
    v_pk_mul_f32 v[58:59], v[58:59], v[142:143]
    v_cvt_pk_bf16_f32 v52, v52, v53
    v_cvt_pk_bf16_f32 v53, v54, v55
    v_cvt_pk_bf16_f32 v54, v56, v57
    v_cvt_pk_bf16_f32 v55, v58, v59
    buffer_store_dwordx4 v[52:55], v3, s[20:23], s28 offen offset:0 sc1
    v_pk_mul_f32 v[136:137], v[100:101], v[100:101]
    v_pk_mul_f32 v[138:139], v[102:103], v[102:103]
    v_pk_mul_f32 v[140:141], v[104:105], v[104:105]
    v_pk_mul_f32 v[142:143], v[106:107], v[106:107]
    v_pk_fma_f32 v[136:137], v[136:137], v[162:163], v[160:161] op_sel:[0,0,1] op_sel_hi:[1,0,1]
    v_pk_fma_f32 v[138:139], v[138:139], v[162:163], v[160:161] op_sel:[0,0,1] op_sel_hi:[1,0,1]
    v_pk_fma_f32 v[140:141], v[140:141], v[162:163], v[160:161] op_sel:[0,0,1] op_sel_hi:[1,0,1]
    v_pk_fma_f32 v[142:143], v[142:143], v[162:163], v[160:161] op_sel:[0,0,1] op_sel_hi:[1,0,1]
    v_pk_mul_f32 v[136:137], v[136:137], v[100:101]
    v_pk_mul_f32 v[138:139], v[138:139], v[102:103]
    v_pk_mul_f32 v[140:141], v[140:141], v[104:105]
    v_pk_mul_f32 v[142:143], v[142:143], v[106:107]
    v_exp_f32 v136, v136
    v_exp_f32 v137, v137
    v_exp_f32 v138, v138
    v_exp_f32 v139, v139
    v_exp_f32 v140, v140
    v_exp_f32 v141, v141
    v_exp_f32 v142, v142
    v_exp_f32 v143, v143
    v_pk_mul_f32 v[100:101], v[100:101], v[108:109]
    v_pk_mul_f32 v[102:103], v[102:103], v[110:111]
    v_pk_mul_f32 v[104:105], v[104:105], v[112:113]
    v_pk_mul_f32 v[106:107], v[106:107], v[114:115]
    v_pk_fma_f32 v[136:137], v[136:137], v[162:163], v[162:163] op_sel:[0,1,1]
    v_pk_fma_f32 v[138:139], v[138:139], v[162:163], v[162:163] op_sel:[0,1,1]
    v_pk_fma_f32 v[140:141], v[140:141], v[162:163], v[162:163] op_sel:[0,1,1]
    v_pk_fma_f32 v[142:143], v[142:143], v[162:163], v[162:163] op_sel:[0,1,1]
    v_rcp_f32 v136, v136
    v_rcp_f32 v137, v137
    v_rcp_f32 v138, v138
    v_rcp_f32 v139, v139
    v_rcp_f32 v140, v140
    v_rcp_f32 v141, v141
    v_rcp_f32 v142, v142
    v_rcp_f32 v143, v143
    v_pk_mul_f32 v[100:101], v[100:101], v[136:137]
    v_pk_mul_f32 v[102:103], v[102:103], v[138:139]
    v_pk_mul_f32 v[104:105], v[104:105], v[140:141]
    v_pk_mul_f32 v[106:107], v[106:107], v[142:143]
    v_cvt_pk_bf16_f32 v100, v100, v101
    v_cvt_pk_bf16_f32 v101, v102, v103
    v_cvt_pk_bf16_f32 v102, v104, v105
    v_cvt_pk_bf16_f32 v103, v106, v107
    buffer_store_dwordx4 v[100:103], v3, s[20:23], s28 offen offset:1024 sc1
    s_mov_b32 s62, 0x17e0000
    v_mov_b32 v4, s84
    v_mov_b32 v5, s85
    s_mov_b64 exec, 0xff
    s_waitcnt vmcnt(0)
    buffer_store_dwordx2 v[4:5], v6, s[20:23], s62 offen sc1
    s_mov_b64 exec, -1
sequential_preLN__softmax_full_mha__geglu_ffn__prompt_kernel_rc_g4:
    s_barrier
    s_lshl_b32 s27, s33, 10
    v_add_u32 v16, s27, v3
    v_and_b32 v19, 3, v0
    v_lshlrev_b32 v19, 3, v19
    v_lshrrev_b32 v20, 5, v0
    v_lshl_add_u32 v19, v20, 9, v19
    v_bfe_u32 v20, v0, 2, 2
    v_lshl_add_u32 v19, v20, 7, v19
    v_bfe_u32 v20, v0, 3, 1
    v_xor_b32 v20, s34, v20
    v_lshl_add_u32 v19, v20, 6, v19
    v_bfe_u32 v20, v0, 4, 1
    v_lshl_add_u32 v19, v20, 5, v19
    v_add_u32 v17, 0x10000, v16
    v_add_u32 v20, 0x10000, v19
    v_add_u32 v18, 0x20000, v16
    v_add_u32 v21, 0x20000, v19
    v_lshlrev_b32 v44, 16, v8
    v_and_b32 v45, s41, v8
    v_lshlrev_b32 v46, 16, v9
    v_and_b32 v47, s41, v9
    v_lshlrev_b32 v48, 16, v10
    v_and_b32 v49, s41, v10
    v_lshlrev_b32 v50, 16, v11
    v_and_b32 v51, s41, v11
    v_lshlrev_b32 v52, 16, v12
    v_and_b32 v53, s41, v12
    v_lshlrev_b32 v54, 16, v13
    v_and_b32 v55, s41, v13
    v_lshlrev_b32 v56, 16, v14
    v_and_b32 v57, s41, v14
    v_lshlrev_b32 v58, 16, v15
    v_and_b32 v59, s41, v15
    s_branch sequential_preLN__softmax_full_mha__geglu_ffn__prompt_kernel_pg_c5
.p2align 12
sequential_preLN__softmax_full_mha__geglu_ffn__prompt_kernel_pg_c5:
    s_barrier
    s_barrier
    ds_read_b128 v[60:63], v16 offset:0
    ds_read_b64_tr_b16 v[76:77], v21 offset:24576
    ds_read_b64_tr_b16 v[78:79], v21 offset:25600
    ds_read_b128 v[64:67], v16 offset:2048
    ds_read_b64_tr_b16 v[80:81], v21 offset:26624
    ds_read_b64_tr_b16 v[82:83], v21 offset:27648
    ds_read_b128 v[68:71], v16 offset:4096
    ds_read_b64_tr_b16 v[84:85], v21 offset:28672
    ds_read_b64_tr_b16 v[86:87], v21 offset:29696
    ds_read_b128 v[72:75], v16 offset:6144
    ds_read_b64_tr_b16 v[88:89], v21 offset:30720
    ds_read_b64_tr_b16 v[90:91], v21 offset:31744
    s_barrier
    ds_read_b128 v[92:95], v16 offset:8192
    ds_read_b64_tr_b16 v[108:109], v20 offset:40960
    ds_read_b64_tr_b16 v[110:111], v20 offset:41984
    s_waitcnt lgkmcnt(3)
    v_mfma_f32_32x32x16_bf16 v[28:43], v[76:79], v[60:63], 0
    ds_read_b128 v[96:99], v16 offset:10240
    ds_read_b64_tr_b16 v[112:113], v20 offset:43008
    ds_read_b64_tr_b16 v[114:115], v20 offset:44032
    v_mfma_f32_32x32x16_bf16 v[28:43], v[80:83], v[64:67], v[28:43]
    ds_read_b128 v[100:103], v16 offset:12288
    ds_read_b64_tr_b16 v[116:117], v20 offset:45056
    ds_read_b64_tr_b16 v[118:119], v20 offset:46080
    v_mfma_f32_32x32x16_bf16 v[28:43], v[84:87], v[68:71], v[28:43]
    ds_read_b128 v[104:107], v16 offset:14336
    ds_read_b64_tr_b16 v[120:121], v20 offset:47104
    ds_read_b64_tr_b16 v[122:123], v20 offset:48128
    v_mfma_f32_32x32x16_bf16 v[28:43], v[88:91], v[72:75], v[28:43]
    s_barrier
    ds_read_b128 v[60:63], v16 offset:16384
    ds_read_b64_tr_b16 v[76:77], v20 offset:49152
    ds_read_b64_tr_b16 v[78:79], v20 offset:50176
    s_waitcnt lgkmcnt(3)
    v_mfma_f32_32x32x16_bf16 v[28:43], v[108:111], v[92:95], v[28:43]
    ds_read_b128 v[64:67], v16 offset:18432
    ds_read_b64_tr_b16 v[80:81], v20 offset:51200
    ds_read_b64_tr_b16 v[82:83], v20 offset:52224
    v_mfma_f32_32x32x16_bf16 v[28:43], v[112:115], v[96:99], v[28:43]
    ds_read_b128 v[68:71], v16 offset:20480
    ds_read_b64_tr_b16 v[84:85], v20 offset:53248
    ds_read_b64_tr_b16 v[86:87], v20 offset:54272
    v_mfma_f32_32x32x16_bf16 v[28:43], v[116:119], v[100:103], v[28:43]
    ds_read_b128 v[72:75], v16 offset:22528
    ds_read_b64_tr_b16 v[88:89], v20 offset:55296
    ds_read_b64_tr_b16 v[90:91], v20 offset:56320
    v_mfma_f32_32x32x16_bf16 v[28:43], v[120:123], v[104:107], v[28:43]
    s_barrier
    ds_read_b128 v[92:95], v16 offset:24576
    ds_read_b64_tr_b16 v[108:109], v20 offset:57344
    ds_read_b64_tr_b16 v[110:111], v20 offset:58368
    s_waitcnt lgkmcnt(3)
    v_mfma_f32_32x32x16_bf16 v[28:43], v[76:79], v[60:63], v[28:43]
    ds_read_b128 v[96:99], v16 offset:26624
    ds_read_b64_tr_b16 v[112:113], v20 offset:59392
    ds_read_b64_tr_b16 v[114:115], v20 offset:60416
    v_mfma_f32_32x32x16_bf16 v[28:43], v[80:83], v[64:67], v[28:43]
    ds_read_b128 v[100:103], v16 offset:28672
    ds_read_b64_tr_b16 v[116:117], v20 offset:61440
    ds_read_b64_tr_b16 v[118:119], v20 offset:62464
    v_mfma_f32_32x32x16_bf16 v[28:43], v[84:87], v[68:71], v[28:43]
    ds_read_b128 v[104:107], v16 offset:30720
    ds_read_b64_tr_b16 v[120:121], v20 offset:63488
    ds_read_b64_tr_b16 v[122:123], v20 offset:64512
    v_mfma_f32_32x32x16_bf16 v[28:43], v[88:91], v[72:75], v[28:43]
    s_barrier
    ds_read_b128 v[60:63], v17 offset:8192
    ds_read_b64_tr_b16 v[76:77], v21 offset:0
    ds_read_b64_tr_b16 v[78:79], v21 offset:1024
    s_waitcnt lgkmcnt(3)
    v_mfma_f32_32x32x16_bf16 v[28:43], v[108:111], v[92:95], v[28:43]
    ds_read_b128 v[64:67], v17 offset:10240
    ds_read_b64_tr_b16 v[80:81], v21 offset:2048
    ds_read_b64_tr_b16 v[82:83], v21 offset:3072
    v_mfma_f32_32x32x16_bf16 v[28:43], v[112:115], v[96:99], v[28:43]
    ds_read_b128 v[68:71], v17 offset:12288
    ds_read_b64_tr_b16 v[84:85], v21 offset:4096
    ds_read_b64_tr_b16 v[86:87], v21 offset:5120
    v_mfma_f32_32x32x16_bf16 v[28:43], v[116:119], v[100:103], v[28:43]
    ds_read_b128 v[72:75], v17 offset:14336
    ds_read_b64_tr_b16 v[88:89], v21 offset:6144
    ds_read_b64_tr_b16 v[90:91], v21 offset:7168
    v_mfma_f32_32x32x16_bf16 v[28:43], v[120:123], v[104:107], v[28:43]
    s_barrier
    ds_read_b128 v[92:95], v17 offset:16384
    ds_read_b64_tr_b16 v[108:109], v21 offset:8192
    ds_read_b64_tr_b16 v[110:111], v21 offset:9216
    s_waitcnt lgkmcnt(3)
    v_mfma_f32_32x32x16_bf16 v[28:43], v[76:79], v[60:63], v[28:43]
    ds_read_b128 v[96:99], v17 offset:18432
    ds_read_b64_tr_b16 v[112:113], v21 offset:10240
    ds_read_b64_tr_b16 v[114:115], v21 offset:11264
    v_mfma_f32_32x32x16_bf16 v[28:43], v[80:83], v[64:67], v[28:43]
    ds_read_b128 v[100:103], v17 offset:20480
    ds_read_b64_tr_b16 v[116:117], v21 offset:12288
    ds_read_b64_tr_b16 v[118:119], v21 offset:13312
    v_mfma_f32_32x32x16_bf16 v[28:43], v[84:87], v[68:71], v[28:43]
    ds_read_b128 v[104:107], v17 offset:22528
    ds_read_b64_tr_b16 v[120:121], v21 offset:14336
    ds_read_b64_tr_b16 v[122:123], v21 offset:15360
    v_mfma_f32_32x32x16_bf16 v[28:43], v[88:91], v[72:75], v[28:43]
    s_barrier
    ds_read_b128 v[60:63], v17 offset:24576
    ds_read_b64_tr_b16 v[76:77], v21 offset:16384
    ds_read_b64_tr_b16 v[78:79], v21 offset:17408
    s_waitcnt lgkmcnt(3)
    v_mfma_f32_32x32x16_bf16 v[28:43], v[108:111], v[92:95], v[28:43]
    ds_read_b128 v[64:67], v17 offset:26624
    ds_read_b64_tr_b16 v[80:81], v21 offset:18432
    ds_read_b64_tr_b16 v[82:83], v21 offset:19456
    v_mfma_f32_32x32x16_bf16 v[28:43], v[112:115], v[96:99], v[28:43]
    ds_read_b128 v[68:71], v17 offset:28672
    ds_read_b64_tr_b16 v[84:85], v21 offset:20480
    ds_read_b64_tr_b16 v[86:87], v21 offset:21504
    v_mfma_f32_32x32x16_bf16 v[28:43], v[116:119], v[100:103], v[28:43]
    ds_read_b128 v[72:75], v17 offset:30720
    ds_read_b64_tr_b16 v[88:89], v21 offset:22528
    ds_read_b64_tr_b16 v[90:91], v21 offset:23552
    v_mfma_f32_32x32x16_bf16 v[28:43], v[120:123], v[104:107], v[28:43]
    s_barrier
    ds_read_b128 v[92:95], v17 offset:32768
    ds_read_b64_tr_b16 v[108:109], v19 offset:32768
    ds_read_b64_tr_b16 v[110:111], v19 offset:33792
    s_waitcnt lgkmcnt(3)
    v_mfma_f32_32x32x16_bf16 v[28:43], v[76:79], v[60:63], v[28:43]
    ds_read_b128 v[96:99], v17 offset:34816
    ds_read_b64_tr_b16 v[112:113], v19 offset:34816
    ds_read_b64_tr_b16 v[114:115], v19 offset:35840
    v_mfma_f32_32x32x16_bf16 v[28:43], v[80:83], v[64:67], v[28:43]
    ds_read_b128 v[100:103], v17 offset:36864
    ds_read_b64_tr_b16 v[116:117], v19 offset:36864
    ds_read_b64_tr_b16 v[118:119], v19 offset:37888
    v_mfma_f32_32x32x16_bf16 v[28:43], v[84:87], v[68:71], v[28:43]
    ds_read_b128 v[104:107], v17 offset:38912
    ds_read_b64_tr_b16 v[120:121], v19 offset:38912
    ds_read_b64_tr_b16 v[122:123], v19 offset:39936
    v_mfma_f32_32x32x16_bf16 v[28:43], v[88:91], v[72:75], v[28:43]
    s_barrier
    ds_read_b128 v[60:63], v16 offset:0
    ds_read_b64_tr_b16 v[76:77], v19 offset:40960
    ds_read_b64_tr_b16 v[78:79], v19 offset:41984
    s_waitcnt lgkmcnt(3)
    v_mfma_f32_32x32x16_bf16 v[28:43], v[108:111], v[92:95], v[28:43]
    ds_read_b128 v[64:67], v16 offset:2048
    ds_read_b64_tr_b16 v[80:81], v19 offset:43008
    ds_read_b64_tr_b16 v[82:83], v19 offset:44032
    v_mfma_f32_32x32x16_bf16 v[28:43], v[112:115], v[96:99], v[28:43]
    ds_read_b128 v[68:71], v16 offset:4096
    ds_read_b64_tr_b16 v[84:85], v19 offset:45056
    ds_read_b64_tr_b16 v[86:87], v19 offset:46080
    v_mfma_f32_32x32x16_bf16 v[28:43], v[116:119], v[100:103], v[28:43]
    ds_read_b128 v[72:75], v16 offset:6144
    ds_read_b64_tr_b16 v[88:89], v19 offset:47104
    ds_read_b64_tr_b16 v[90:91], v19 offset:48128
    v_mfma_f32_32x32x16_bf16 v[28:43], v[120:123], v[104:107], v[28:43]
    s_barrier
    ds_read_b128 v[92:95], v16 offset:8192
    ds_read_b64_tr_b16 v[108:109], v19 offset:49152
    ds_read_b64_tr_b16 v[110:111], v19 offset:50176
    s_waitcnt lgkmcnt(3)
    v_mfma_f32_32x32x16_bf16 v[28:43], v[76:79], v[60:63], v[28:43]
    ds_read_b128 v[96:99], v16 offset:10240
    ds_read_b64_tr_b16 v[112:113], v19 offset:51200
    ds_read_b64_tr_b16 v[114:115], v19 offset:52224
    v_mfma_f32_32x32x16_bf16 v[28:43], v[80:83], v[64:67], v[28:43]
    ds_read_b128 v[100:103], v16 offset:12288
    ds_read_b64_tr_b16 v[116:117], v19 offset:53248
    ds_read_b64_tr_b16 v[118:119], v19 offset:54272
    v_mfma_f32_32x32x16_bf16 v[28:43], v[84:87], v[68:71], v[28:43]
    ds_read_b128 v[104:107], v16 offset:14336
    ds_read_b64_tr_b16 v[120:121], v19 offset:55296
    ds_read_b64_tr_b16 v[122:123], v19 offset:56320
    v_mfma_f32_32x32x16_bf16 v[28:43], v[88:91], v[72:75], v[28:43]
    s_barrier
    ds_read_b128 v[60:63], v16 offset:16384
    ds_read_b64_tr_b16 v[76:77], v19 offset:57344
    ds_read_b64_tr_b16 v[78:79], v19 offset:58368
    s_waitcnt lgkmcnt(3)
    v_mfma_f32_32x32x16_bf16 v[28:43], v[108:111], v[92:95], v[28:43]
    ds_read_b128 v[64:67], v16 offset:18432
    ds_read_b64_tr_b16 v[80:81], v19 offset:59392
    ds_read_b64_tr_b16 v[82:83], v19 offset:60416
    v_mfma_f32_32x32x16_bf16 v[28:43], v[112:115], v[96:99], v[28:43]
    ds_read_b128 v[68:71], v16 offset:20480
    ds_read_b64_tr_b16 v[84:85], v19 offset:61440
    ds_read_b64_tr_b16 v[86:87], v19 offset:62464
    v_mfma_f32_32x32x16_bf16 v[28:43], v[116:119], v[100:103], v[28:43]
    ds_read_b128 v[72:75], v16 offset:22528
    ds_read_b64_tr_b16 v[88:89], v19 offset:63488
    ds_read_b64_tr_b16 v[90:91], v19 offset:64512
    v_mfma_f32_32x32x16_bf16 v[28:43], v[120:123], v[104:107], v[28:43]
    s_barrier
    ds_read_b128 v[92:95], v16 offset:24576
    ds_read_b64_tr_b16 v[108:109], v20 offset:0
    ds_read_b64_tr_b16 v[110:111], v20 offset:1024
    s_waitcnt lgkmcnt(3)
    v_mfma_f32_32x32x16_bf16 v[28:43], v[76:79], v[60:63], v[28:43]
    ds_read_b128 v[96:99], v16 offset:26624
    ds_read_b64_tr_b16 v[112:113], v20 offset:2048
    ds_read_b64_tr_b16 v[114:115], v20 offset:3072
    v_mfma_f32_32x32x16_bf16 v[28:43], v[80:83], v[64:67], v[28:43]
    ds_read_b128 v[100:103], v16 offset:28672
    ds_read_b64_tr_b16 v[116:117], v20 offset:4096
    ds_read_b64_tr_b16 v[118:119], v20 offset:5120
    v_mfma_f32_32x32x16_bf16 v[28:43], v[84:87], v[68:71], v[28:43]
    ds_read_b128 v[104:107], v16 offset:30720
    ds_read_b64_tr_b16 v[120:121], v20 offset:6144
    ds_read_b64_tr_b16 v[122:123], v20 offset:7168
    v_mfma_f32_32x32x16_bf16 v[28:43], v[88:91], v[72:75], v[28:43]
    s_barrier
    ds_read_b128 v[60:63], v17 offset:8192
    ds_read_b64_tr_b16 v[76:77], v21 offset:24576
    ds_read_b64_tr_b16 v[78:79], v21 offset:25600
    s_waitcnt lgkmcnt(3)
    v_mfma_f32_32x32x16_bf16 v[28:43], v[108:111], v[92:95], v[28:43]
    ds_read_b128 v[64:67], v17 offset:10240
    ds_read_b64_tr_b16 v[80:81], v21 offset:26624
    ds_read_b64_tr_b16 v[82:83], v21 offset:27648
    v_mfma_f32_32x32x16_bf16 v[28:43], v[112:115], v[96:99], v[28:43]
    ds_read_b128 v[68:71], v17 offset:12288
    ds_read_b64_tr_b16 v[84:85], v21 offset:28672
    ds_read_b64_tr_b16 v[86:87], v21 offset:29696
    v_mfma_f32_32x32x16_bf16 v[28:43], v[116:119], v[100:103], v[28:43]
    ds_read_b128 v[72:75], v17 offset:14336
    ds_read_b64_tr_b16 v[88:89], v21 offset:30720
    ds_read_b64_tr_b16 v[90:91], v21 offset:31744
    v_mfma_f32_32x32x16_bf16 v[28:43], v[120:123], v[104:107], v[28:43]
    s_barrier
    ds_read_b128 v[92:95], v17 offset:16384
    ds_read_b64_tr_b16 v[108:109], v20 offset:40960
    ds_read_b64_tr_b16 v[110:111], v20 offset:41984
    s_waitcnt lgkmcnt(3)
    v_mfma_f32_32x32x16_bf16 v[28:43], v[76:79], v[60:63], v[28:43]
    ds_read_b128 v[96:99], v17 offset:18432
    ds_read_b64_tr_b16 v[112:113], v20 offset:43008
    ds_read_b64_tr_b16 v[114:115], v20 offset:44032
    v_mfma_f32_32x32x16_bf16 v[28:43], v[80:83], v[64:67], v[28:43]
    ds_read_b128 v[100:103], v17 offset:20480
    ds_read_b64_tr_b16 v[116:117], v20 offset:45056
    ds_read_b64_tr_b16 v[118:119], v20 offset:46080
    v_mfma_f32_32x32x16_bf16 v[28:43], v[84:87], v[68:71], v[28:43]
    ds_read_b128 v[104:107], v17 offset:22528
    ds_read_b64_tr_b16 v[120:121], v20 offset:47104
    ds_read_b64_tr_b16 v[122:123], v20 offset:48128
    v_mfma_f32_32x32x16_bf16 v[28:43], v[88:91], v[72:75], v[28:43]
    s_barrier
    ds_read_b128 v[60:63], v17 offset:24576
    ds_read_b64_tr_b16 v[76:77], v20 offset:49152
    ds_read_b64_tr_b16 v[78:79], v20 offset:50176
    s_waitcnt lgkmcnt(3)
    v_mfma_f32_32x32x16_bf16 v[28:43], v[108:111], v[92:95], v[28:43]
    ds_read_b128 v[64:67], v17 offset:26624
    ds_read_b64_tr_b16 v[80:81], v20 offset:51200
    ds_read_b64_tr_b16 v[82:83], v20 offset:52224
    v_mfma_f32_32x32x16_bf16 v[28:43], v[112:115], v[96:99], v[28:43]
    ds_read_b128 v[68:71], v17 offset:28672
    ds_read_b64_tr_b16 v[84:85], v20 offset:53248
    ds_read_b64_tr_b16 v[86:87], v20 offset:54272
    v_mfma_f32_32x32x16_bf16 v[28:43], v[116:119], v[100:103], v[28:43]
    ds_read_b128 v[72:75], v17 offset:30720
    ds_read_b64_tr_b16 v[88:89], v20 offset:55296
    ds_read_b64_tr_b16 v[90:91], v20 offset:56320
    v_mfma_f32_32x32x16_bf16 v[28:43], v[120:123], v[104:107], v[28:43]
    s_barrier
    ds_read_b128 v[92:95], v17 offset:32768
    ds_read_b64_tr_b16 v[108:109], v20 offset:57344
    ds_read_b64_tr_b16 v[110:111], v20 offset:58368
    s_waitcnt lgkmcnt(3)
    v_mfma_f32_32x32x16_bf16 v[28:43], v[76:79], v[60:63], v[28:43]
    ds_read_b128 v[96:99], v17 offset:34816
    ds_read_b64_tr_b16 v[112:113], v20 offset:59392
    ds_read_b64_tr_b16 v[114:115], v20 offset:60416
    v_mfma_f32_32x32x16_bf16 v[28:43], v[80:83], v[64:67], v[28:43]
    ds_read_b128 v[100:103], v17 offset:36864
    ds_read_b64_tr_b16 v[116:117], v20 offset:61440
    ds_read_b64_tr_b16 v[118:119], v20 offset:62464
    v_mfma_f32_32x32x16_bf16 v[28:43], v[84:87], v[68:71], v[28:43]
    ds_read_b128 v[104:107], v17 offset:38912
    ds_read_b64_tr_b16 v[120:121], v20 offset:63488
    ds_read_b64_tr_b16 v[122:123], v20 offset:64512
    v_mfma_f32_32x32x16_bf16 v[28:43], v[88:91], v[72:75], v[28:43]
    s_barrier
    ds_read_b128 v[60:63], v16 offset:0
    ds_read_b64_tr_b16 v[76:77], v21 offset:0
    ds_read_b64_tr_b16 v[78:79], v21 offset:1024
    s_waitcnt lgkmcnt(3)
    v_mfma_f32_32x32x16_bf16 v[28:43], v[108:111], v[92:95], v[28:43]
    ds_read_b128 v[64:67], v16 offset:2048
    ds_read_b64_tr_b16 v[80:81], v21 offset:2048
    ds_read_b64_tr_b16 v[82:83], v21 offset:3072
    v_mfma_f32_32x32x16_bf16 v[28:43], v[112:115], v[96:99], v[28:43]
    ds_read_b128 v[68:71], v16 offset:4096
    ds_read_b64_tr_b16 v[84:85], v21 offset:4096
    ds_read_b64_tr_b16 v[86:87], v21 offset:5120
    v_mfma_f32_32x32x16_bf16 v[28:43], v[116:119], v[100:103], v[28:43]
    ds_read_b128 v[72:75], v16 offset:6144
    ds_read_b64_tr_b16 v[88:89], v21 offset:6144
    ds_read_b64_tr_b16 v[90:91], v21 offset:7168
    v_mfma_f32_32x32x16_bf16 v[28:43], v[120:123], v[104:107], v[28:43]
    s_barrier
    ds_read_b128 v[92:95], v16 offset:8192
    ds_read_b64_tr_b16 v[108:109], v21 offset:8192
    ds_read_b64_tr_b16 v[110:111], v21 offset:9216
    s_waitcnt lgkmcnt(3)
    v_mfma_f32_32x32x16_bf16 v[28:43], v[76:79], v[60:63], v[28:43]
    ds_read_b128 v[96:99], v16 offset:10240
    ds_read_b64_tr_b16 v[112:113], v21 offset:10240
    ds_read_b64_tr_b16 v[114:115], v21 offset:11264
    v_mfma_f32_32x32x16_bf16 v[28:43], v[80:83], v[64:67], v[28:43]
    ds_read_b128 v[100:103], v16 offset:12288
    ds_read_b64_tr_b16 v[116:117], v21 offset:12288
    ds_read_b64_tr_b16 v[118:119], v21 offset:13312
    v_mfma_f32_32x32x16_bf16 v[28:43], v[84:87], v[68:71], v[28:43]
    ds_read_b128 v[104:107], v16 offset:14336
    ds_read_b64_tr_b16 v[120:121], v21 offset:14336
    ds_read_b64_tr_b16 v[122:123], v21 offset:15360
    v_mfma_f32_32x32x16_bf16 v[28:43], v[88:91], v[72:75], v[28:43]
    s_barrier
    ds_read_b128 v[60:63], v16 offset:16384
    ds_read_b64_tr_b16 v[76:77], v21 offset:16384
    ds_read_b64_tr_b16 v[78:79], v21 offset:17408
    s_waitcnt lgkmcnt(3)
    v_mfma_f32_32x32x16_bf16 v[28:43], v[108:111], v[92:95], v[28:43]
    ds_read_b128 v[64:67], v16 offset:18432
    ds_read_b64_tr_b16 v[80:81], v21 offset:18432
    ds_read_b64_tr_b16 v[82:83], v21 offset:19456
    v_mfma_f32_32x32x16_bf16 v[28:43], v[112:115], v[96:99], v[28:43]
    ds_read_b128 v[68:71], v16 offset:20480
    ds_read_b64_tr_b16 v[84:85], v21 offset:20480
    ds_read_b64_tr_b16 v[86:87], v21 offset:21504
    v_mfma_f32_32x32x16_bf16 v[28:43], v[116:119], v[100:103], v[28:43]
    ds_read_b128 v[72:75], v16 offset:22528
    ds_read_b64_tr_b16 v[88:89], v21 offset:22528
    ds_read_b64_tr_b16 v[90:91], v21 offset:23552
    v_mfma_f32_32x32x16_bf16 v[28:43], v[120:123], v[104:107], v[28:43]
    s_barrier
    ds_read_b128 v[92:95], v16 offset:24576
    ds_read_b64_tr_b16 v[108:109], v19 offset:32768
    ds_read_b64_tr_b16 v[110:111], v19 offset:33792
    s_waitcnt lgkmcnt(3)
    v_mfma_f32_32x32x16_bf16 v[28:43], v[76:79], v[60:63], v[28:43]
    ds_read_b128 v[96:99], v16 offset:26624
    ds_read_b64_tr_b16 v[112:113], v19 offset:34816
    ds_read_b64_tr_b16 v[114:115], v19 offset:35840
    v_mfma_f32_32x32x16_bf16 v[28:43], v[80:83], v[64:67], v[28:43]
    ds_read_b128 v[100:103], v16 offset:28672
    ds_read_b64_tr_b16 v[116:117], v19 offset:36864
    ds_read_b64_tr_b16 v[118:119], v19 offset:37888
    v_mfma_f32_32x32x16_bf16 v[28:43], v[84:87], v[68:71], v[28:43]
    ds_read_b128 v[104:107], v16 offset:30720
    ds_read_b64_tr_b16 v[120:121], v19 offset:38912
    ds_read_b64_tr_b16 v[122:123], v19 offset:39936
    v_mfma_f32_32x32x16_bf16 v[28:43], v[88:91], v[72:75], v[28:43]
    s_barrier
    ds_read_b128 v[60:63], v17 offset:8192
    ds_read_b64_tr_b16 v[76:77], v19 offset:40960
    ds_read_b64_tr_b16 v[78:79], v19 offset:41984
    s_waitcnt lgkmcnt(3)
    v_mfma_f32_32x32x16_bf16 v[28:43], v[108:111], v[92:95], v[28:43]
    ds_read_b128 v[64:67], v17 offset:10240
    ds_read_b64_tr_b16 v[80:81], v19 offset:43008
    ds_read_b64_tr_b16 v[82:83], v19 offset:44032
    v_mfma_f32_32x32x16_bf16 v[28:43], v[112:115], v[96:99], v[28:43]
    ds_read_b128 v[68:71], v17 offset:12288
    ds_read_b64_tr_b16 v[84:85], v19 offset:45056
    ds_read_b64_tr_b16 v[86:87], v19 offset:46080
    v_mfma_f32_32x32x16_bf16 v[28:43], v[116:119], v[100:103], v[28:43]
    ds_read_b128 v[72:75], v17 offset:14336
    ds_read_b64_tr_b16 v[88:89], v19 offset:47104
    ds_read_b64_tr_b16 v[90:91], v19 offset:48128
    v_mfma_f32_32x32x16_bf16 v[28:43], v[120:123], v[104:107], v[28:43]
    s_barrier
    ds_read_b128 v[92:95], v17 offset:16384
    ds_read_b64_tr_b16 v[108:109], v19 offset:49152
    ds_read_b64_tr_b16 v[110:111], v19 offset:50176
    s_waitcnt lgkmcnt(3)
    v_mfma_f32_32x32x16_bf16 v[28:43], v[76:79], v[60:63], v[28:43]
    ds_read_b128 v[96:99], v17 offset:18432
    ds_read_b64_tr_b16 v[112:113], v19 offset:51200
    ds_read_b64_tr_b16 v[114:115], v19 offset:52224
    v_mfma_f32_32x32x16_bf16 v[28:43], v[80:83], v[64:67], v[28:43]
    ds_read_b128 v[100:103], v17 offset:20480
    ds_read_b64_tr_b16 v[116:117], v19 offset:53248
    ds_read_b64_tr_b16 v[118:119], v19 offset:54272
    v_mfma_f32_32x32x16_bf16 v[28:43], v[84:87], v[68:71], v[28:43]
    ds_read_b128 v[104:107], v17 offset:22528
    ds_read_b64_tr_b16 v[120:121], v19 offset:55296
    ds_read_b64_tr_b16 v[122:123], v19 offset:56320
    v_mfma_f32_32x32x16_bf16 v[28:43], v[88:91], v[72:75], v[28:43]
    s_waitcnt lgkmcnt(9)
    v_mfma_f32_32x32x16_bf16 v[28:43], v[108:111], v[92:95], v[28:43]
    s_waitcnt lgkmcnt(6)
    v_mfma_f32_32x32x16_bf16 v[28:43], v[112:115], v[96:99], v[28:43]
    s_waitcnt lgkmcnt(3)
    v_mfma_f32_32x32x16_bf16 v[28:43], v[116:119], v[100:103], v[28:43]
    s_waitcnt lgkmcnt(0)
    v_mfma_f32_32x32x16_bf16 v[28:43], v[120:123], v[104:107], v[28:43]
    s_nop 7
    s_nop 3
    v_cvt_pk_bf16_f32 v8, v28, v29
    v_cvt_pk_bf16_f32 v9, v30, v31
    v_cvt_pk_bf16_f32 v10, v32, v33
    v_cvt_pk_bf16_f32 v11, v34, v35
    v_cvt_pk_bf16_f32 v12, v36, v37
    v_cvt_pk_bf16_f32 v13, v38, v39
    v_cvt_pk_bf16_f32 v14, v40, v41
    v_cvt_pk_bf16_f32 v15, v42, v43
    v_lshlrev_b32 v28, 16, v8
    v_and_b32 v29, s41, v8
    v_lshlrev_b32 v30, 16, v9
    v_and_b32 v31, s41, v9
    v_lshlrev_b32 v32, 16, v10
    v_and_b32 v33, s41, v10
    v_lshlrev_b32 v34, 16, v11
    v_and_b32 v35, s41, v11
    v_lshlrev_b32 v36, 16, v12
    v_and_b32 v37, s41, v12
    v_lshlrev_b32 v38, 16, v13
    v_and_b32 v39, s41, v13
    v_lshlrev_b32 v40, 16, v14
    v_and_b32 v41, s41, v14
    v_lshlrev_b32 v42, 16, v15
    v_and_b32 v43, s41, v15
    v_pk_add_f32 v[28:29], v[28:29], v[44:45]
    v_pk_add_f32 v[30:31], v[30:31], v[46:47]
    v_pk_add_f32 v[32:33], v[32:33], v[48:49]
    v_pk_add_f32 v[34:35], v[34:35], v[50:51]
    v_pk_add_f32 v[36:37], v[36:37], v[52:53]
    v_pk_add_f32 v[38:39], v[38:39], v[54:55]
    v_pk_add_f32 v[40:41], v[40:41], v[56:57]
    v_pk_add_f32 v[42:43], v[42:43], v[58:59]
    v_cvt_pk_bf16_f32 v8, v28, v29
    v_cvt_pk_bf16_f32 v9, v30, v31
    v_cvt_pk_bf16_f32 v10, v32, v33
    v_cvt_pk_bf16_f32 v11, v34, v35
    v_cvt_pk_bf16_f32 v12, v36, v37
    v_cvt_pk_bf16_f32 v13, v38, v39
    v_cvt_pk_bf16_f32 v14, v40, v41
    v_cvt_pk_bf16_f32 v15, v42, v43
    v_permlane32_swap_b32 v8, v10
    v_permlane32_swap_b32 v9, v11
    buffer_store_dwordx4 v[8:11], v7, s[12:15], s29 offen
    v_permlane32_swap_b32 v12, v14
    v_permlane32_swap_b32 v13, v15
    buffer_store_dwordx4 v[12:15], v7, s[12:15], s29 offen offset:32
sequential_preLN__softmax_full_mha__geglu_ffn__prompt_kernel_fin:
sequential_preLN__softmax_full_mha__geglu_ffn__prompt_kernel_exit:
    s_endpgm
.section .rodata,"a"
.p2align 6
.amdhsa_kernel sequential_preLN__softmax_full_mha__geglu_ffn__prompt_kernel
  .amdhsa_next_free_vgpr 164
  .amdhsa_next_free_sgpr 96
  .amdhsa_accum_offset 164
  .amdhsa_group_segment_fixed_size 0
  .amdhsa_kernarg_size 80
  .amdhsa_user_sgpr_count 2
  .amdhsa_user_sgpr_kernarg_segment_ptr 1
  .amdhsa_system_sgpr_workgroup_id_x 1
.end_amdhsa_kernel
```
